```python
import torch

def _softmax(x, axis=-1):
    return torch.softmax(x, dim=axis)

def _gelu(x):
    return torch.nn.functional.gelu(x, approximate='tanh')

def _silu(x):
    return torch.nn.functional.silu(x)

def _sigmoid(x):
    return torch.sigmoid(x)

def _layernorm(x, axis=-1, eps=1e-05):
    m = x.mean(dim=axis, keepdim=True)
    v = x.var(dim=axis, keepdim=True, unbiased=False)
    return (x - m) / torch.sqrt(v + eps)

def _scatter_add(tgt, idx, src, axis=0):
    return tgt.clone().index_add_(axis, idx, src)

def _segment_sum(src, seg, n):
    out = torch.zeros((n,) + src.shape[1:], dtype=src.dtype)
    return out.index_add_(0, seg, src)

def _pad(x, pw):
    flat = tuple((v for pair in reversed(pw) for v in pair))
    return torch.nn.functional.pad(x, flat)
kernel_name = 'standalone__varlen_attn_packed__ragged'

def setup_inputs():

    _w = lambda a: (lambda t: t.to(torch.bfloat16) if t.is_floating_point() else t)(torch.as_tensor(a))
    cu = torch.tensor([0, 321, 555, 878, 1299, 1551, 1670, 1878, 2181, 2351, 2646, 2810, 3248, 3471, 3811, 4169, 4391], dtype=torch.int64)
    T, H, D = (int(cu[-1]), 16, 128)
    return {'q': _w((lambda *s: torch.randn(*s, dtype=torch.bfloat16) * 0.8)(T, H, D)), 'k': _w((lambda *s: torch.randn(*s, dtype=torch.bfloat16) * 0.8)(T, H, D)), 'v': _w((lambda *s: torch.randn(*s, dtype=torch.bfloat16) * 0.05)(T, H, D)), 'cu': _w(cu)}

def reference(q, k, v, cu):
    T, H, D = q.shape
    out = torch.zeros_like(q)
    scale = D ** (-0.5)
    outs = []
    for i in range(len(cu) - 1):
        s, e = (int(cu[i]), int(cu[i + 1]))
        qi, ki, vi = (q[s:e].clone(), k[s:e].clone(), v[s:e].clone())
        p = _softmax(torch.einsum('qhd,khd->hqk', qi, ki) * scale, axis=-1)
        outs.append(torch.einsum('hqk,khd->qhd', p, vi))
    return torch.concatenate(outs, axis=0)
```

```asm
; @launch grid=(512,1,1) block=(256,1,1) lds=76032
.amdgcn_target "amdgcn-amd-amdhsa--gfx950"
.text
.globl standalone__varlen_attn_packed__ragged_kernel
.p2align 8
.type standalone__varlen_attn_packed__ragged_kernel,@function
standalone__varlen_attn_packed__ragged_kernel:
    s_cmp_ge_u32 s2, 512
    s_cbranch_scc1 L_end
    s_getpc_b64 s[46:47]
L_pc:
    s_load_dwordx4 s[4:7], s[0:1], 0
    s_lshl_b32 s3, s2, 5
    s_add_u32 s3, s3, L_table-L_pc
    s_add_u32 s46, s46, s3
    s_addc_u32 s47, s47, 0
    s_load_dwordx8 s[12:19], s[46:47], 0
    s_load_dwordx2 s[8:9], s[0:1], 16
    s_load_dwordx2 s[10:11], s[0:1], 32
    v_and_b32 v10, 63, v0
    v_lshrrev_b32 v11, 6, v0
    v_lshrrev_b32 v12, 4, v10
    v_readfirstlane_b32 s32, v11
    v_and_b32 v13, 15, v10
    v_lshlrev_b32 v1, 4, v13
    v_lshl_add_u32 v236, v12, 15, v1
    s_lshl_b32 s45, s32, 13
    v_add_u32 v1, s45, v236
    v_add_u32 v2, 3040, v1
    s_mul_i32 s39, s32, 2112
    s_add_u32 s40, s39, 76032
    s_add_u32 s43, s32, 7
    s_cmp_ge_u32 s32, 2
    s_cselect_b32 s43, s32, s43
    s_mul_i32 s43, s43, 8448
    s_mov_b32 s23, 0x20000
    s_mov_b32 s27, 0x20000
    s_mov_b32 s31, 0x20000
    s_waitcnt lgkmcnt(0)
    s_and_b32 s7, s7, 0xffff
    s_mov_b64 s[20:21], s[6:7]
    s_mov_b32 s22, s14
    s_mov_b32 s33, s12
    s_and_b32 s5, s5, 0xffff
    s_add_u32 m0, s39, 33792
    s_mov_b64 s[28:29], s[4:5]
    buffer_load_dwordx4 v1, s[20:23], s33 offen lds
    s_mov_b32 s30, s14
    s_lshr_b32 s3, s15, 22
    buffer_load_dwordx4 v2, s[20:23], s33 offen offset:1056 lds
    s_bitcmp1_b32 s15, 24
    s_cbranch_scc0 L_lw2
    s_waitcnt vmcnt(0)
L_lw2:
    s_add_u32 s33, s33, 131072
    s_add_u32 m0, s39, 42240
    s_mov_b32 s24, s8
    buffer_load_dwordx4 v1, s[20:23], s33 offen lds
    s_and_b32 s25, s9, 0xffff
    buffer_load_dwordx4 v2, s[20:23], s33 offen offset:1056 lds
    s_bitcmp1_b32 s15, 25
    s_cbranch_scc0 L_lw4
    s_waitcnt vmcnt(0)
L_lw4:
    s_add_u32 s33, s33, 131072
    s_add_u32 s3, s3, s32
    s_and_b32 s3, s3, 3
    s_lshl_b32 s3, s3, 17
    s_add_u32 s46, s13, s3
    s_mov_b32 s26, s14
    s_mov_b32 s34, s12
    s_add_u32 m0, s43, 0
    s_nop 0
    buffer_load_dwordx4 v236, s[28:31], s46 offen lds
    s_add_u32 m0, s43, 1056
    s_add_u32 s46, s46, 4096
    buffer_load_dwordx4 v236, s[28:31], s46 offen lds
    s_bitcmp1_b32 s15, 26
    s_cbranch_scc0 L_lw6
    s_waitcnt vmcnt(0)
L_lw6:
    s_add_u32 m0, s43, 2112
    s_add_u32 s46, s46, 4096
    buffer_load_dwordx4 v236, s[28:31], s46 offen lds
    s_add_u32 m0, s43, 3168
    s_add_u32 s46, s46, 4096
    buffer_load_dwordx4 v236, s[28:31], s46 offen lds
    s_bitcmp1_b32 s15, 27
    s_cbranch_scc0 L_lw8
    s_waitcnt vmcnt(0)
L_lw8:
    s_add_u32 m0, s43, 4224
    s_add_u32 s46, s46, 4096
    buffer_load_dwordx4 v236, s[28:31], s46 offen lds
    s_add_u32 m0, s43, 5280
    s_add_u32 s46, s46, 4096
    buffer_load_dwordx4 v236, s[28:31], s46 offen lds
    s_add_u32 m0, s43, 6336
    s_add_u32 s46, s46, 4096
    buffer_load_dwordx4 v236, s[28:31], s46 offen lds
    s_add_u32 m0, s43, 7392
    s_add_u32 s46, s46, 4096
    buffer_load_dwordx4 v236, s[28:31], s46 offen lds
    s_add_u32 m0, s39, 0
    s_sub_u32 s43, s43, 76032
    buffer_load_dwordx4 v1, s[24:27], s34 offen lds
    buffer_load_dwordx4 v2, s[24:27], s34 offen offset:1056 lds
    s_add_u32 s34, s34, 131072
    s_add_u32 m0, s39, 50688
    s_nop 0
    buffer_load_dwordx4 v1, s[20:23], s33 offen lds
    buffer_load_dwordx4 v2, s[20:23], s33 offen offset:1056 lds
    s_add_u32 s33, s33, 131072
    s_add_u32 m0, s39, 8448
    s_nop 0
    buffer_load_dwordx4 v1, s[24:27], s34 offen lds
    buffer_load_dwordx4 v2, s[24:27], s34 offen offset:1056 lds
    s_add_u32 s34, s34, 131072
    s_bfe_u32 s49, s15, 0x20014
    s_setprio 3
    v_and_b32 v11, 7, v10
    v_mul_u32_u24 v3, 1056, v11
    v_bfe_u32 v237, v10, 3, 1
    v_lshl_add_u32 v3, v237, 8, v3
    v_lshl_add_u32 v3, v12, 4, v3
    v_add_u32 v3, 76032, v3
    v_add_u32 v5, s43, v3
    v_bfe_u32 v4, v10, 2, 3
    v_mul_u32_u24 v4, 1056, v4
    v_lshrrev_b32 v14, 5, v10
    v_lshl_add_u32 v4, v14, 8, v4
    v_and_b32 v15, 3, v10
    v_lshl_add_u32 v4, v15, 3, v4
    v_xor_b32 v7, v14, v11
    v_lshlrev_b32 v7, 4, v7
    v_lshl_add_u32 v7, v13, 7, v7
    v_and_b32 v15, 1, v12
    v_xor_b32 v15, v15, v237
    v_lshl_add_u32 v7, v15, 3, v7
    s_and_b32 s45, s32, 1
    s_lshl_b32 s45, s45, 12
    v_add_u32 v7, s45, v7
    v_lshrrev_b32 v15, 3, v10
    v_xor_b32 v8, v15, v11
    v_lshlrev_b32 v8, 4, v8
    v_lshl_add_u32 v8, v15, 7, v8
    v_add_u32 v8, s45, v8
    v_lshlrev_b32 v9, 12, v15
    v_lshl_add_u32 v9, v11, 4, v9
    v_mov_b32 v224, 0
    v_mov_b32 v225, 0
    v_mov_b32 v226, 0
    v_mov_b32 v227, 0
    v_mov_b32 v228, 0
    v_mov_b32 v229, 0
    v_mov_b32 v230, 0
    v_mov_b32 v231, 0
    s_mov_b32 s50, 0x3e0293ee
    s_mov_b32 s52, 0x46800000
    s_mov_b32 s63, 0x2b800000
    s_mov_b32 s28, s10
    s_and_b32 s29, s11, 0xffff
    s_mov_b32 s43, 0xffff5b00
    s_mov_b32 s44, 16896
    s_mov_b32 s37, 25344
    s_mov_b32 s62, 1
    s_add_u32 s45, s3, s13
    s_cmp_ge_u32 s45, s14
    s_cbranch_scc1 L_p1I
    s_waitcnt vmcnt(6)
    ds_read_b128 v[160:163], v5 offset:0
    ds_read_b128 v[176:179], v5 offset:512
    ds_read_b128 v[164:167], v5 offset:64
    ds_read_b128 v[180:183], v5 offset:576
    ds_read_b128 v[168:171], v5 offset:128
    ds_read_b128 v[184:187], v5 offset:640
    ds_read_b128 v[172:175], v5 offset:192
    ds_read_b128 v[188:191], v5 offset:704
    v_add_u32 v5, s43, v3
    s_waitcnt lgkmcnt(0)
    s_barrier
    ds_read_b128 v[192:195], v5 offset:0
    ds_read_b128 v[208:211], v5 offset:512
    ds_read_b128 v[196:199], v5 offset:64
    ds_read_b128 v[212:215], v5 offset:576
    ds_read_b128 v[200:203], v5 offset:128
    ds_read_b128 v[216:219], v5 offset:640
    ds_read_b128 v[204:207], v5 offset:192
    ds_read_b128 v[220:223], v5 offset:704
    v_lshlrev_b32 v128, 16, v160
    v_and_b32 v129, 0xffff0000, v160
    v_lshlrev_b32 v130, 16, v161
    v_and_b32 v131, 0xffff0000, v161
    v_mul_f32 v128, s50, v128
    v_mul_f32 v129, s50, v129
    v_mul_f32 v130, s50, v130
    v_mul_f32 v131, s50, v131
    v_cvt_pk_bf16_f32 v16, v128, v129
    v_cvt_pk_bf16_f32 v17, v130, v131
    s_add_u32 m0, s39, 59136
    v_lshlrev_b32 v132, 16, v162
    v_and_b32 v133, 0xffff0000, v162
    v_lshlrev_b32 v134, 16, v163
    v_and_b32 v135, 0xffff0000, v163
    v_mul_f32 v132, s50, v132
    buffer_load_dwordx4 v1, s[20:23], s33 offen lds
    v_mul_f32 v133, s50, v133
    v_mul_f32 v134, s50, v134
    v_mul_f32 v135, s50, v135
    v_cvt_pk_bf16_f32 v18, v132, v133
    v_cvt_pk_bf16_f32 v19, v134, v135
    v_lshlrev_b32 v136, 16, v176
    v_and_b32 v137, 0xffff0000, v176
    v_lshlrev_b32 v138, 16, v177
    v_and_b32 v139, 0xffff0000, v177
    v_mul_f32 v136, s50, v136
    v_mul_f32 v137, s50, v137
    v_mul_f32 v138, s50, v138
    v_mul_f32 v139, s50, v139
    v_cvt_pk_bf16_f32 v32, v136, v137
    v_cvt_pk_bf16_f32 v33, v138, v139
    buffer_load_dwordx4 v2, s[20:23], s33 offen offset:1056 lds
    s_add_u32 s33, s33, 131072
    v_lshlrev_b32 v140, 16, v178
    v_and_b32 v141, 0xffff0000, v178
    v_lshlrev_b32 v142, 16, v179
    v_and_b32 v143, 0xffff0000, v179
    v_mul_f32 v140, s50, v140
    v_mul_f32 v141, s50, v141
    v_mul_f32 v142, s50, v142
    v_mul_f32 v143, s50, v143
    v_cvt_pk_bf16_f32 v34, v140, v141
    v_cvt_pk_bf16_f32 v35, v142, v143
    s_nop 1
    s_waitcnt lgkmcnt(7)
    v_mfma_f32_16x16x32_bf16 v[112:115], v[192:195], v[16:19], v[224:227]
    v_lshlrev_b32 v128, 16, v164
    v_and_b32 v129, 0xffff0000, v164
    v_lshlrev_b32 v130, 16, v165
    v_and_b32 v131, 0xffff0000, v165
    v_mul_f32 v128, s50, v128
    v_mul_f32 v129, s50, v129
    v_mul_f32 v130, s50, v130
    v_mul_f32 v131, s50, v131
    v_cvt_pk_bf16_f32 v20, v128, v129
    v_cvt_pk_bf16_f32 v21, v130, v131
    v_mfma_f32_16x16x32_bf16 v[120:123], v[192:195], v[32:35], v[228:231]
    s_add_u32 m0, s39, 67584
    v_lshlrev_b32 v132, 16, v166
    v_and_b32 v133, 0xffff0000, v166
    v_lshlrev_b32 v134, 16, v167
    v_and_b32 v135, 0xffff0000, v167
    v_mul_f32 v132, s50, v132
    v_mul_f32 v133, s50, v133
    v_mul_f32 v134, s50, v134
    v_mul_f32 v135, s50, v135
    v_cvt_pk_bf16_f32 v22, v132, v133
    v_cvt_pk_bf16_f32 v23, v134, v135
    s_waitcnt lgkmcnt(6)
    v_mfma_f32_16x16x32_bf16 v[124:127], v[208:211], v[32:35], v[228:231]
    buffer_load_dwordx4 v1, s[20:23], s33 offen lds
    v_lshlrev_b32 v136, 16, v180
    v_and_b32 v137, 0xffff0000, v180
    v_lshlrev_b32 v138, 16, v181
    v_and_b32 v139, 0xffff0000, v181
    v_mul_f32 v136, s50, v136
    v_mul_f32 v137, s50, v137
    v_mul_f32 v138, s50, v138
    v_mul_f32 v139, s50, v139
    v_cvt_pk_bf16_f32 v36, v136, v137
    v_cvt_pk_bf16_f32 v37, v138, v139
    v_mfma_f32_16x16x32_bf16 v[116:119], v[208:211], v[16:19], v[224:227]
    v_lshlrev_b32 v140, 16, v182
    v_and_b32 v141, 0xffff0000, v182
    v_lshlrev_b32 v142, 16, v183
    v_and_b32 v143, 0xffff0000, v183
    v_mul_f32 v140, s50, v140
    v_mul_f32 v141, s50, v141
    v_mul_f32 v142, s50, v142
    v_mul_f32 v143, s50, v143
    v_cvt_pk_bf16_f32 v38, v140, v141
    v_cvt_pk_bf16_f32 v39, v142, v143
    s_nop 1
    s_waitcnt lgkmcnt(5)
    v_mfma_f32_16x16x32_bf16 v[112:115], v[196:199], v[20:23], v[112:115]
    v_lshlrev_b32 v128, 16, v168
    v_and_b32 v129, 0xffff0000, v168
    v_lshlrev_b32 v130, 16, v169
    v_and_b32 v131, 0xffff0000, v169
    v_mul_f32 v128, s50, v128
    v_mul_f32 v129, s50, v129
    v_mul_f32 v130, s50, v130
    v_mul_f32 v131, s50, v131
    v_cvt_pk_bf16_f32 v24, v128, v129
    v_cvt_pk_bf16_f32 v25, v130, v131
    v_mfma_f32_16x16x32_bf16 v[120:123], v[196:199], v[36:39], v[120:123]
    buffer_load_dwordx4 v2, s[20:23], s33 offen offset:1056 lds
    v_lshlrev_b32 v132, 16, v170
    v_and_b32 v133, 0xffff0000, v170
    v_lshlrev_b32 v134, 16, v171
    v_and_b32 v135, 0xffff0000, v171
    v_mul_f32 v132, s50, v132
    v_mul_f32 v133, s50, v133
    v_mul_f32 v134, s50, v134
    v_mul_f32 v135, s50, v135
    v_cvt_pk_bf16_f32 v26, v132, v133
    v_cvt_pk_bf16_f32 v27, v134, v135
    s_waitcnt lgkmcnt(4)
    v_mfma_f32_16x16x32_bf16 v[124:127], v[212:215], v[36:39], v[124:127]
    s_add_u32 s33, s33, 131072
    v_lshlrev_b32 v136, 16, v184
    v_and_b32 v137, 0xffff0000, v184
    v_lshlrev_b32 v138, 16, v185
    v_and_b32 v139, 0xffff0000, v185
    v_mul_f32 v136, s50, v136
    v_mul_f32 v137, s50, v137
    v_mul_f32 v138, s50, v138
    v_mul_f32 v139, s50, v139
    v_cvt_pk_bf16_f32 v40, v136, v137
    v_cvt_pk_bf16_f32 v41, v138, v139
    v_mfma_f32_16x16x32_bf16 v[116:119], v[212:215], v[20:23], v[116:119]
    v_lshlrev_b32 v140, 16, v186
    v_and_b32 v141, 0xffff0000, v186
    v_lshlrev_b32 v142, 16, v187
    v_and_b32 v143, 0xffff0000, v187
    v_mul_f32 v140, s50, v140
    v_mul_f32 v141, s50, v141
    v_mul_f32 v142, s50, v142
    v_mul_f32 v143, s50, v143
    v_cvt_pk_bf16_f32 v42, v140, v141
    v_cvt_pk_bf16_f32 v43, v142, v143
    s_nop 1
    s_waitcnt lgkmcnt(3)
    v_mfma_f32_16x16x32_bf16 v[112:115], v[200:203], v[24:27], v[112:115]
    v_lshlrev_b32 v128, 16, v172
    v_and_b32 v129, 0xffff0000, v172
    v_lshlrev_b32 v130, 16, v173
    v_and_b32 v131, 0xffff0000, v173
    v_mul_f32 v128, s50, v128
    v_mul_f32 v129, s50, v129
    v_mul_f32 v130, s50, v130
    v_mul_f32 v131, s50, v131
    v_cvt_pk_bf16_f32 v28, v128, v129
    v_cvt_pk_bf16_f32 v29, v130, v131
    v_mfma_f32_16x16x32_bf16 v[120:123], v[200:203], v[40:43], v[120:123]
    v_lshlrev_b32 v132, 16, v174
    v_and_b32 v133, 0xffff0000, v174
    v_lshlrev_b32 v134, 16, v175
    v_and_b32 v135, 0xffff0000, v175
    v_mul_f32 v132, s50, v132
    v_mul_f32 v133, s50, v133
    v_mul_f32 v134, s50, v134
    v_mul_f32 v135, s50, v135
    v_cvt_pk_bf16_f32 v30, v132, v133
    v_cvt_pk_bf16_f32 v31, v134, v135
    s_waitcnt lgkmcnt(2)
    v_mfma_f32_16x16x32_bf16 v[124:127], v[216:219], v[40:43], v[124:127]
    v_lshlrev_b32 v136, 16, v188
    v_and_b32 v137, 0xffff0000, v188
    v_lshlrev_b32 v138, 16, v189
    v_and_b32 v139, 0xffff0000, v189
    v_mul_f32 v136, s50, v136
    v_mul_f32 v137, s50, v137
    v_mul_f32 v138, s50, v138
    v_mul_f32 v139, s50, v139
    v_cvt_pk_bf16_f32 v44, v136, v137
    v_cvt_pk_bf16_f32 v45, v138, v139
    v_mfma_f32_16x16x32_bf16 v[116:119], v[216:219], v[24:27], v[116:119]
    v_lshlrev_b32 v140, 16, v190
    v_and_b32 v141, 0xffff0000, v190
    v_lshlrev_b32 v142, 16, v191
    v_and_b32 v143, 0xffff0000, v191
    v_mul_f32 v140, s50, v140
    v_mul_f32 v141, s50, v141
    v_mul_f32 v142, s50, v142
    v_mul_f32 v143, s50, v143
    v_cvt_pk_bf16_f32 v46, v140, v141
    v_cvt_pk_bf16_f32 v47, v142, v143
    s_nop 1
    s_waitcnt lgkmcnt(1)
    v_mfma_f32_16x16x32_bf16 v[112:115], v[204:207], v[28:31], v[112:115]
    v_mfma_f32_16x16x32_bf16 v[120:123], v[204:207], v[44:47], v[120:123]
    s_waitcnt lgkmcnt(0)
    v_mfma_f32_16x16x32_bf16 v[124:127], v[220:223], v[44:47], v[124:127]
    v_mfma_f32_16x16x32_bf16 v[116:119], v[220:223], v[28:31], v[116:119]
    s_waitcnt vmcnt(6)
L_pre0:
    s_add_u32 s51, s43, 8448
    s_cselect_b32 s51, 0xffff5b00, s51
    v_add_u32 v5, s51, v3
    s_add_u32 m0, s39, s44
    s_cmp_eq_u32 s49, 0
    s_setprio 1
    s_cbranch_scc1 L_pr1
    s_setprio 2
L_pr1:
    s_barrier
    ds_read_b128 v[160:163], v5 offset:0
    ds_read_b128 v[176:179], v5 offset:512
    ds_read_b128 v[164:167], v5 offset:64
    ds_read_b128 v[180:183], v5 offset:576
    ds_read_b128 v[168:171], v5 offset:128
    ds_read_b128 v[184:187], v5 offset:640
    ds_read_b128 v[172:175], v5 offset:192
    ds_read_b128 v[188:191], v5 offset:704
    buffer_load_dwordx4 v1, s[24:27], s34 offen lds
    s_and_b32 s45, s15, 0xff
    s_cmp_eq_u32 s19, 0
    s_cselect_b32 s46, 2, 6
    s_cselect_b32 s42, 1, 0
    s_sub_u32 s41, s45, s46
    s_add_u32 s38, s37, 8448
    s_cmp_ge_u32 s38, 33792
    s_cselect_b32 s38, 0, s38
    v_add_u32 v6, s38, v4
    s_add_u32 s35, s51, 8448
    s_cselect_b32 s35, 0xffff5b00, s35
    v_add_u32 v5, s35, v3
    buffer_load_dwordx4 v2, s[24:27], s34 offen offset:1056 lds
    s_add_u32 s34, s34, 131072
    s_add_u32 s45, s3, s13
    s_cmp_ge_u32 s45, s14
    s_cbranch_scc1 L_step0I
L_step0:
    s_waitcnt lgkmcnt(7)
    v_mfma_f32_16x16x32_bf16 v[128:131], v[160:163], v[16:19], v[224:227]
    v_exp_f32 v236, v112
    v_mfma_f32_16x16x32_bf16 v[136:139], v[160:163], v[32:35], v[228:231]
    s_add_u32 m0, s40, s43
    v_exp_f32 v237, v113
    v_mov_b32 v232, v236
    s_waitcnt lgkmcnt(6)
    v_mfma_f32_16x16x32_bf16 v[140:143], v[176:179], v[32:35], v[228:231]
    buffer_load_dwordx4 v1, s[20:23], s33 offen lds
    v_exp_f32 v238, v114
    v_add_f32 v232, v232, v237
    v_cvt_pk_bf16_f32 v144, v236, v237
    v_mfma_f32_16x16x32_bf16 v[132:135], v[176:179], v[16:19], v[224:227]
    v_exp_f32 v239, v115
    v_add_f32 v232, v232, v238
    s_waitcnt lgkmcnt(5)
    v_mfma_f32_16x16x32_bf16 v[128:131], v[164:167], v[20:23], v[128:131]
    ds_read_b128 v[160:163], v5 offset:0
    v_exp_f32 v236, v116
    v_add_f32 v232, v232, v239
    v_cvt_pk_bf16_f32 v145, v238, v239
    v_mfma_f32_16x16x32_bf16 v[136:139], v[164:167], v[36:39], v[136:139]
    ds_read_b128 v[176:179], v5 offset:512
    v_exp_f32 v237, v117
    v_add_f32 v232, v232, v236
    s_waitcnt lgkmcnt(6)
    v_mfma_f32_16x16x32_bf16 v[140:143], v[180:183], v[36:39], v[140:143]
    buffer_load_dwordx4 v2, s[20:23], s33 offen offset:1056 lds
    v_exp_f32 v238, v118
    v_add_f32 v232, v232, v237
    v_cvt_pk_bf16_f32 v146, v236, v237
    v_mfma_f32_16x16x32_bf16 v[132:135], v[180:183], v[20:23], v[132:135]
    s_add_u32 s33, s33, 131072
    v_exp_f32 v239, v119
    v_add_f32 v232, v232, v238
    s_waitcnt lgkmcnt(5)
    v_mfma_f32_16x16x32_bf16 v[128:131], v[168:171], v[24:27], v[128:131]
    ds_read_b128 v[164:167], v5 offset:64
    v_exp_f32 v236, v120
    v_add_f32 v232, v232, v239
    v_cvt_pk_bf16_f32 v147, v238, v239
    v_mfma_f32_16x16x32_bf16 v[136:139], v[168:171], v[40:43], v[136:139]
    ds_read_b128 v[180:183], v5 offset:576
    v_exp_f32 v237, v121
    v_mov_b32 v233, v236
    s_waitcnt lgkmcnt(6)
    v_mfma_f32_16x16x32_bf16 v[140:143], v[184:187], v[40:43], v[140:143]
    s_add_u32 s36, s35, 8448
    s_cselect_b32 s36, 0xffff5b00, s36
    v_exp_f32 v238, v122
    v_add_f32 v233, v233, v237
    v_cvt_pk_bf16_f32 v148, v236, v237
    v_mfma_f32_16x16x32_bf16 v[132:135], v[184:187], v[24:27], v[132:135]
    s_sub_u32 s41, s41, 1
    s_cbranch_scc1 L_evS
L_retSx:
    v_exp_f32 v239, v123
    v_add_f32 v233, v233, v238
    s_waitcnt lgkmcnt(5)
    v_mfma_f32_16x16x32_bf16 v[128:131], v[172:175], v[28:31], v[128:131]
    ds_read_b128 v[168:171], v5 offset:128
    v_exp_f32 v236, v124
    v_add_f32 v233, v233, v239
    v_cvt_pk_bf16_f32 v149, v238, v239
    v_mfma_f32_16x16x32_bf16 v[136:139], v[172:175], v[44:47], v[136:139]
    ds_read_b128 v[184:187], v5 offset:640
    v_exp_f32 v237, v125
    v_add_f32 v233, v233, v236
    s_waitcnt lgkmcnt(6)
    v_mfma_f32_16x16x32_bf16 v[140:143], v[188:191], v[44:47], v[140:143]
    ds_read_b128 v[172:175], v5 offset:192
    v_exp_f32 v238, v126
    v_add_f32 v233, v233, v237
    v_cvt_pk_bf16_f32 v150, v236, v237
    v_mfma_f32_16x16x32_bf16 v[132:135], v[188:191], v[28:31], v[132:135]
    ds_read_b128 v[188:191], v5 offset:704
    v_exp_f32 v239, v127
    v_add_f32 v233, v233, v238
    s_add_u32 m0, s40, s51
    v_add_f32 v233, v233, v239
    v_cvt_pk_bf16_f32 v151, v238, v239
    v_add_u32 v5, s36, v3
    v_subrev_u32 v11, s63, v232
    v_subrev_u32 v12, s63, v233
    s_sub_u32 s45, s52, s63
    v_max_u32 v11, v11, v12
    v_cmp_lt_u32 vcc, s45, v11
    s_cmp_eq_u32 s62, 0
    s_cbranch_scc1 L_s0w
    s_waitcnt vmcnt(6)
L_s0w:
    s_cbranch_vccnz L_fbS
L_fbretS:
L_retF:
    s_waitcnt vmcnt(10) lgkmcnt(0)
    s_barrier
    v_mfma_f32_16x16x32_bf16 v[112:115], v[160:163], v[16:19], v[224:227]
    ds_read_b64_tr_b16 v[192:193], v6 offset:0
    v_exp_f32 v236, v128
    v_mfma_f32_16x16x32_bf16 v[120:123], v[160:163], v[32:35], v[228:231]
    ds_read_b64_tr_b16 v[194:195], v6 offset:512
    buffer_load_dwordx4 v1, s[20:23], s33 offen lds
    v_exp_f32 v237, v129
    v_mfma_f32_16x16x32_bf16 v[124:127], v[176:179], v[32:35], v[228:231]
    ds_read_b64_tr_b16 v[196:197], v6 offset:32
    v_add_f32 v234, v232, v236
    v_cvt_pk_bf16_f32 v152, v236, v237
    v_mfma_f32_16x16x32_bf16 v[116:119], v[176:179], v[16:19], v[224:227]
    ds_read_b64_tr_b16 v[198:199], v6 offset:544
    v_exp_f32 v238, v130
    v_mfma_f32_16x16x32_bf16 v[112:115], v[164:167], v[20:23], v[112:115]
    ds_read_b64_tr_b16 v[200:201], v6 offset:64
    buffer_load_dwordx4 v2, s[20:23], s33 offen offset:1056 lds
    v_exp_f32 v239, v131
    v_mfma_f32_16x16x32_bf16 v[120:123], v[164:167], v[36:39], v[120:123]
    ds_read_b64_tr_b16 v[202:203], v6 offset:576
    s_add_u32 s33, s33, 131072
    v_add_f32 v234, v234, v237
    v_add_f32 v234, v234, v238
    v_mfma_f32_16x16x32_bf16 v[124:127], v[180:183], v[36:39], v[124:127]
    ds_read_b64_tr_b16 v[204:205], v6 offset:96
    s_sub_u32 s41, s41, 1
    s_cbranch_scc1 L_evF
L_retFx:
    v_add_f32 v234, v234, v239
    v_cvt_pk_bf16_f32 v153, v238, v239
    v_mfma_f32_16x16x32_bf16 v[116:119], v[180:183], v[20:23], v[116:119]
    ds_read_b64_tr_b16 v[206:207], v6 offset:608
    v_exp_f32 v236, v132
    v_mfma_f32_16x16x32_bf16 v[112:115], v[168:171], v[24:27], v[112:115]
    ds_read_b64_tr_b16 v[208:209], v6 offset:128
    v_exp_f32 v237, v133
    v_mfma_f32_16x16x32_bf16 v[120:123], v[168:171], v[40:43], v[120:123]
    ds_read_b64_tr_b16 v[210:211], v6 offset:640
    v_add_f32 v234, v234, v236
    v_cvt_pk_bf16_f32 v154, v236, v237
    v_mfma_f32_16x16x32_bf16 v[124:127], v[184:187], v[40:43], v[124:127]
    ds_read_b64_tr_b16 v[212:213], v6 offset:160
    v_exp_f32 v238, v134
    v_mfma_f32_16x16x32_bf16 v[116:119], v[184:187], v[24:27], v[116:119]
    ds_read_b64_tr_b16 v[214:215], v6 offset:672
    v_exp_f32 v239, v135
    v_mfma_f32_16x16x32_bf16 v[112:115], v[172:175], v[28:31], v[112:115]
    ds_read_b64_tr_b16 v[216:217], v6 offset:192
    v_add_f32 v234, v234, v237
    v_add_f32 v234, v234, v238
    v_mfma_f32_16x16x32_bf16 v[120:123], v[172:175], v[44:47], v[120:123]
    ds_read_b64_tr_b16 v[218:219], v6 offset:704
    v_add_f32 v234, v234, v239
    v_cvt_pk_bf16_f32 v155, v238, v239
    v_mfma_f32_16x16x32_bf16 v[124:127], v[188:191], v[44:47], v[124:127]
    ds_read_b64_tr_b16 v[220:221], v6 offset:224
    v_exp_f32 v236, v136
    v_mfma_f32_16x16x32_bf16 v[116:119], v[188:191], v[28:31], v[116:119]
    ds_read_b64_tr_b16 v[222:223], v6 offset:736
    v_exp_f32 v237, v137
    s_waitcnt lgkmcnt(8)
    v_mfma_f32_16x16x32_bf16 v[48:51], v[192:195], v[144:147], 0
    ds_read_b128 v[160:163], v5 offset:0
    v_add_f32 v235, v233, v236
    v_cvt_pk_bf16_f32 v156, v236, v237
    v_mfma_f32_16x16x32_bf16 v[52:55], v[192:195], v[148:151], 0
    ds_read_b128 v[176:179], v5 offset:512
    v_exp_f32 v238, v138
    v_mfma_f32_16x16x32_bf16 v[60:63], v[196:199], v[148:151], 0
    ds_read_b128 v[164:167], v5 offset:64
    v_exp_f32 v239, v139
    v_mfma_f32_16x16x32_bf16 v[56:59], v[196:199], v[144:147], 0
    ds_read_b128 v[180:183], v5 offset:576
    v_add_f32 v235, v235, v237
    v_add_f32 v235, v235, v238
    v_mfma_f32_16x16x32_bf16 v[64:67], v[200:203], v[144:147], 0
    ds_read_b128 v[168:171], v5 offset:128
    v_add_f32 v235, v235, v239
    v_cvt_pk_bf16_f32 v157, v238, v239
    v_mfma_f32_16x16x32_bf16 v[68:71], v[200:203], v[148:151], 0
    ds_read_b128 v[184:187], v5 offset:640
    v_exp_f32 v236, v140
    v_mfma_f32_16x16x32_bf16 v[76:79], v[204:207], v[148:151], 0
    ds_read_b128 v[172:175], v5 offset:192
    v_exp_f32 v237, v141
    v_mfma_f32_16x16x32_bf16 v[72:75], v[204:207], v[144:147], 0
    ds_read_b128 v[188:191], v5 offset:704
    s_add_u32 m0, s39, s37
    v_add_f32 v235, v235, v236
    v_cvt_pk_bf16_f32 v158, v236, v237
    s_waitcnt lgkmcnt(8)
    v_mfma_f32_16x16x32_bf16 v[80:83], v[208:211], v[144:147], 0
    buffer_load_dwordx4 v1, s[24:27], s34 offen lds
    v_exp_f32 v238, v142
    v_mfma_f32_16x16x32_bf16 v[84:87], v[208:211], v[148:151], 0
    s_xor_b32 s37, s37, 0x4200
    v_exp_f32 v239, v143
    v_mfma_f32_16x16x32_bf16 v[92:95], v[212:215], v[148:151], 0
    buffer_load_dwordx4 v2, s[24:27], s34 offen offset:1056 lds
    v_add_f32 v235, v235, v237
    v_add_f32 v235, v235, v238
    v_mfma_f32_16x16x32_bf16 v[88:91], v[212:215], v[144:147], 0
    s_add_u32 m0, s40, s35
    v_add_f32 v235, v235, v239
    v_cvt_pk_bf16_f32 v159, v238, v239
    v_mfma_f32_16x16x32_bf16 v[96:99], v[216:219], v[144:147], 0
    buffer_load_dwordx4 v1, s[20:23], s33 offen lds
    v_max_f32 v11, v234, v235
    v_cmp_lt_f32 vcc, s52, v11
    v_mfma_f32_16x16x32_bf16 v[100:103], v[216:219], v[148:151], 0
    s_add_u32 s34, s34, 131072
    v_add_u32 v6, s37, v4
    v_mfma_f32_16x16x32_bf16 v[108:111], v[220:223], v[148:151], 0
    buffer_load_dwordx4 v2, s[20:23], s33 offen offset:1056 lds
    s_add_u32 s35, s36, 8448
    s_cselect_b32 s35, 0xffff5b00, s35
    v_mfma_f32_16x16x32_bf16 v[104:107], v[220:223], v[144:147], 0
    s_add_u32 s33, s33, 131072
    v_add_u32 v5, s35, v3
    s_sub_u32 s41, s41, 1
    s_cbranch_vccnz L_fbF
L_fbretF:
    s_cbranch_scc1 L_ev0
L_ret0:
    s_waitcnt vmcnt(10) lgkmcnt(0)
    s_barrier
    v_mfma_f32_16x16x32_bf16 v[128:131], v[160:163], v[16:19], v[224:227]
    ds_read_b64_tr_b16 v[192:193], v6 offset:0
    s_add_u32 m0, s39, s38
    v_exp_f32 v236, v112
    v_mfma_f32_16x16x32_bf16 v[136:139], v[160:163], v[32:35], v[228:231]
    ds_read_b64_tr_b16 v[194:195], v6 offset:512
    buffer_load_dwordx4 v1, s[24:27], s34 offen lds
    v_exp_f32 v237, v113
    v_mfma_f32_16x16x32_bf16 v[140:143], v[176:179], v[32:35], v[228:231]
    ds_read_b64_tr_b16 v[196:197], v6 offset:32
    s_xor_b32 s38, s38, 0x4200
    v_add_f32 v232, v234, v236
    v_cvt_pk_bf16_f32 v144, v236, v237
    v_mfma_f32_16x16x32_bf16 v[132:135], v[176:179], v[16:19], v[224:227]
    ds_read_b64_tr_b16 v[198:199], v6 offset:544
    buffer_load_dwordx4 v2, s[24:27], s34 offen offset:1056 lds
    v_exp_f32 v238, v114
    v_mfma_f32_16x16x32_bf16 v[128:131], v[164:167], v[20:23], v[128:131]
    ds_read_b64_tr_b16 v[200:201], v6 offset:64
    v_exp_f32 v239, v115
    v_mfma_f32_16x16x32_bf16 v[136:139], v[164:167], v[36:39], v[136:139]
    ds_read_b64_tr_b16 v[202:203], v6 offset:576
    v_add_f32 v232, v232, v237
    v_add_f32 v232, v232, v238
    v_mfma_f32_16x16x32_bf16 v[140:143], v[180:183], v[36:39], v[140:143]
    ds_read_b64_tr_b16 v[204:205], v6 offset:96
    v_add_f32 v232, v232, v239
    v_cvt_pk_bf16_f32 v145, v238, v239
    v_mfma_f32_16x16x32_bf16 v[132:135], v[180:183], v[20:23], v[132:135]
    ds_read_b64_tr_b16 v[206:207], v6 offset:608
    v_exp_f32 v236, v116
    v_mfma_f32_16x16x32_bf16 v[128:131], v[168:171], v[24:27], v[128:131]
    ds_read_b64_tr_b16 v[208:209], v6 offset:128
    v_exp_f32 v237, v117
    v_mfma_f32_16x16x32_bf16 v[136:139], v[168:171], v[40:43], v[136:139]
    ds_read_b64_tr_b16 v[210:211], v6 offset:640
    v_add_f32 v232, v232, v236
    v_cvt_pk_bf16_f32 v146, v236, v237
    v_mfma_f32_16x16x32_bf16 v[140:143], v[184:187], v[40:43], v[140:143]
    ds_read_b64_tr_b16 v[212:213], v6 offset:160
    v_exp_f32 v238, v118
    v_mfma_f32_16x16x32_bf16 v[132:135], v[184:187], v[24:27], v[132:135]
    ds_read_b64_tr_b16 v[214:215], v6 offset:672
    v_exp_f32 v239, v119
    v_mfma_f32_16x16x32_bf16 v[128:131], v[172:175], v[28:31], v[128:131]
    ds_read_b64_tr_b16 v[216:217], v6 offset:192
    v_add_f32 v232, v232, v237
    v_add_f32 v232, v232, v238
    v_mfma_f32_16x16x32_bf16 v[136:139], v[172:175], v[44:47], v[136:139]
    ds_read_b64_tr_b16 v[218:219], v6 offset:704
    v_add_f32 v232, v232, v239
    v_cvt_pk_bf16_f32 v147, v238, v239
    v_mfma_f32_16x16x32_bf16 v[140:143], v[188:191], v[44:47], v[140:143]
    ds_read_b64_tr_b16 v[220:221], v6 offset:224
    v_exp_f32 v236, v120
    v_mfma_f32_16x16x32_bf16 v[132:135], v[188:191], v[28:31], v[132:135]
    ds_read_b64_tr_b16 v[222:223], v6 offset:736
    v_exp_f32 v237, v121
    s_waitcnt lgkmcnt(8)
    v_mfma_f32_16x16x32_bf16 v[48:51], v[192:195], v[152:155], v[48:51]
    ds_read_b128 v[160:163], v5 offset:0
    v_add_f32 v233, v235, v236
    v_cvt_pk_bf16_f32 v148, v236, v237
    v_mfma_f32_16x16x32_bf16 v[52:55], v[192:195], v[156:159], v[52:55]
    ds_read_b128 v[176:179], v5 offset:512
    v_exp_f32 v238, v122
    v_mfma_f32_16x16x32_bf16 v[60:63], v[196:199], v[156:159], v[60:63]
    ds_read_b128 v[164:167], v5 offset:64
    v_exp_f32 v239, v123
    v_mfma_f32_16x16x32_bf16 v[56:59], v[196:199], v[152:155], v[56:59]
    ds_read_b128 v[180:183], v5 offset:576
    v_add_f32 v233, v233, v237
    v_add_f32 v233, v233, v238
    v_mfma_f32_16x16x32_bf16 v[64:67], v[200:203], v[152:155], v[64:67]
    ds_read_b128 v[168:171], v5 offset:128
    v_add_f32 v233, v233, v239
    v_cvt_pk_bf16_f32 v149, v238, v239
    v_mfma_f32_16x16x32_bf16 v[68:71], v[200:203], v[156:159], v[68:71]
    ds_read_b128 v[184:187], v5 offset:640
    v_exp_f32 v236, v124
    v_mfma_f32_16x16x32_bf16 v[76:79], v[204:207], v[156:159], v[76:79]
    ds_read_b128 v[172:175], v5 offset:192
    v_exp_f32 v237, v125
    v_mfma_f32_16x16x32_bf16 v[72:75], v[204:207], v[152:155], v[72:75]
    ds_read_b128 v[188:191], v5 offset:704
    v_add_f32 v233, v233, v236
    v_cvt_pk_bf16_f32 v150, v236, v237
    s_waitcnt lgkmcnt(8)
    v_mfma_f32_16x16x32_bf16 v[80:83], v[208:211], v[152:155], v[80:83]
    v_exp_f32 v238, v126
    v_mfma_f32_16x16x32_bf16 v[84:87], v[208:211], v[156:159], v[84:87]
    v_exp_f32 v239, v127
    v_mfma_f32_16x16x32_bf16 v[92:95], v[212:215], v[156:159], v[92:95]
    v_add_f32 v233, v233, v237
    v_add_f32 v233, v233, v238
    v_mfma_f32_16x16x32_bf16 v[88:91], v[212:215], v[152:155], v[88:91]
    s_add_u32 m0, s40, s36
    v_add_f32 v233, v233, v239
    v_cvt_pk_bf16_f32 v151, v238, v239
    v_mfma_f32_16x16x32_bf16 v[96:99], v[216:219], v[152:155], v[96:99]
    buffer_load_dwordx4 v1, s[20:23], s33 offen lds
    v_max_f32 v11, v232, v233
    v_cmp_lt_f32 vcc, s52, v11
    v_mfma_f32_16x16x32_bf16 v[100:103], v[216:219], v[156:159], v[100:103]
    s_add_u32 s34, s34, 131072
    v_add_u32 v6, s38, v4
    v_mfma_f32_16x16x32_bf16 v[108:111], v[220:223], v[156:159], v[108:111]
    buffer_load_dwordx4 v2, s[20:23], s33 offen offset:1056 lds
    s_add_u32 s36, s35, 8448
    s_cselect_b32 s36, 0xffff5b00, s36
    v_mfma_f32_16x16x32_bf16 v[104:107], v[220:223], v[152:155], v[104:107]
    s_add_u32 s33, s33, 131072
    v_add_u32 v5, s36, v3
    s_sub_u32 s41, s41, 1
    s_cbranch_vccnz L_fb0
L_fbret0:
    s_cbranch_scc1 L_ev1
L_ret1:
    s_waitcnt vmcnt(10) lgkmcnt(0)
    s_barrier
    v_mfma_f32_16x16x32_bf16 v[112:115], v[160:163], v[16:19], v[224:227]
    ds_read_b64_tr_b16 v[192:193], v6 offset:0
    s_add_u32 m0, s39, s37
    v_exp_f32 v236, v128
    v_mfma_f32_16x16x32_bf16 v[120:123], v[160:163], v[32:35], v[228:231]
    ds_read_b64_tr_b16 v[194:195], v6 offset:512
    buffer_load_dwordx4 v1, s[24:27], s34 offen lds
    v_exp_f32 v237, v129
    v_mfma_f32_16x16x32_bf16 v[124:127], v[176:179], v[32:35], v[228:231]
    ds_read_b64_tr_b16 v[196:197], v6 offset:32
    s_xor_b32 s37, s37, 0x4200
    v_add_f32 v234, v232, v236
    v_cvt_pk_bf16_f32 v152, v236, v237
    v_mfma_f32_16x16x32_bf16 v[116:119], v[176:179], v[16:19], v[224:227]
    ds_read_b64_tr_b16 v[198:199], v6 offset:544
    buffer_load_dwordx4 v2, s[24:27], s34 offen offset:1056 lds
    v_exp_f32 v238, v130
    v_mfma_f32_16x16x32_bf16 v[112:115], v[164:167], v[20:23], v[112:115]
    ds_read_b64_tr_b16 v[200:201], v6 offset:64
    v_exp_f32 v239, v131
    v_mfma_f32_16x16x32_bf16 v[120:123], v[164:167], v[36:39], v[120:123]
    ds_read_b64_tr_b16 v[202:203], v6 offset:576
    v_add_f32 v234, v234, v237
    v_add_f32 v234, v234, v238
    v_mfma_f32_16x16x32_bf16 v[124:127], v[180:183], v[36:39], v[124:127]
    ds_read_b64_tr_b16 v[204:205], v6 offset:96
    v_add_f32 v234, v234, v239
    v_cvt_pk_bf16_f32 v153, v238, v239
    v_mfma_f32_16x16x32_bf16 v[116:119], v[180:183], v[20:23], v[116:119]
    ds_read_b64_tr_b16 v[206:207], v6 offset:608
    v_exp_f32 v236, v132
    v_mfma_f32_16x16x32_bf16 v[112:115], v[168:171], v[24:27], v[112:115]
    ds_read_b64_tr_b16 v[208:209], v6 offset:128
    v_exp_f32 v237, v133
    v_mfma_f32_16x16x32_bf16 v[120:123], v[168:171], v[40:43], v[120:123]
    ds_read_b64_tr_b16 v[210:211], v6 offset:640
    v_add_f32 v234, v234, v236
    v_cvt_pk_bf16_f32 v154, v236, v237
    v_mfma_f32_16x16x32_bf16 v[124:127], v[184:187], v[40:43], v[124:127]
    ds_read_b64_tr_b16 v[212:213], v6 offset:160
    v_exp_f32 v238, v134
    v_mfma_f32_16x16x32_bf16 v[116:119], v[184:187], v[24:27], v[116:119]
    ds_read_b64_tr_b16 v[214:215], v6 offset:672
    v_exp_f32 v239, v135
    v_mfma_f32_16x16x32_bf16 v[112:115], v[172:175], v[28:31], v[112:115]
    ds_read_b64_tr_b16 v[216:217], v6 offset:192
    v_add_f32 v234, v234, v237
    v_add_f32 v234, v234, v238
    v_mfma_f32_16x16x32_bf16 v[120:123], v[172:175], v[44:47], v[120:123]
    ds_read_b64_tr_b16 v[218:219], v6 offset:704
    v_add_f32 v234, v234, v239
    v_cvt_pk_bf16_f32 v155, v238, v239
    v_mfma_f32_16x16x32_bf16 v[124:127], v[188:191], v[44:47], v[124:127]
    ds_read_b64_tr_b16 v[220:221], v6 offset:224
    v_exp_f32 v236, v136
    v_mfma_f32_16x16x32_bf16 v[116:119], v[188:191], v[28:31], v[116:119]
    ds_read_b64_tr_b16 v[222:223], v6 offset:736
    v_exp_f32 v237, v137
    s_waitcnt lgkmcnt(8)
    v_mfma_f32_16x16x32_bf16 v[48:51], v[192:195], v[144:147], v[48:51]
    ds_read_b128 v[160:163], v5 offset:0
    v_add_f32 v235, v233, v236
    v_cvt_pk_bf16_f32 v156, v236, v237
    v_mfma_f32_16x16x32_bf16 v[52:55], v[192:195], v[148:151], v[52:55]
    ds_read_b128 v[176:179], v5 offset:512
    v_exp_f32 v238, v138
    v_mfma_f32_16x16x32_bf16 v[60:63], v[196:199], v[148:151], v[60:63]
    ds_read_b128 v[164:167], v5 offset:64
    v_exp_f32 v239, v139
    v_mfma_f32_16x16x32_bf16 v[56:59], v[196:199], v[144:147], v[56:59]
    ds_read_b128 v[180:183], v5 offset:576
    v_add_f32 v235, v235, v237
    v_add_f32 v235, v235, v238
    v_mfma_f32_16x16x32_bf16 v[64:67], v[200:203], v[144:147], v[64:67]
    ds_read_b128 v[168:171], v5 offset:128
    v_add_f32 v235, v235, v239
    v_cvt_pk_bf16_f32 v157, v238, v239
    v_mfma_f32_16x16x32_bf16 v[68:71], v[200:203], v[148:151], v[68:71]
    ds_read_b128 v[184:187], v5 offset:640
    v_exp_f32 v236, v140
    v_mfma_f32_16x16x32_bf16 v[76:79], v[204:207], v[148:151], v[76:79]
    ds_read_b128 v[172:175], v5 offset:192
    v_exp_f32 v237, v141
    v_mfma_f32_16x16x32_bf16 v[72:75], v[204:207], v[144:147], v[72:75]
    ds_read_b128 v[188:191], v5 offset:704
    v_add_f32 v235, v235, v236
    v_cvt_pk_bf16_f32 v158, v236, v237
    s_waitcnt lgkmcnt(8)
    v_mfma_f32_16x16x32_bf16 v[80:83], v[208:211], v[144:147], v[80:83]
    v_exp_f32 v238, v142
    v_mfma_f32_16x16x32_bf16 v[84:87], v[208:211], v[148:151], v[84:87]
    v_exp_f32 v239, v143
    v_mfma_f32_16x16x32_bf16 v[92:95], v[212:215], v[148:151], v[92:95]
    v_add_f32 v235, v235, v237
    v_add_f32 v235, v235, v238
    v_mfma_f32_16x16x32_bf16 v[88:91], v[212:215], v[144:147], v[88:91]
    s_add_u32 m0, s40, s35
    v_add_f32 v235, v235, v239
    v_cvt_pk_bf16_f32 v159, v238, v239
    v_mfma_f32_16x16x32_bf16 v[96:99], v[216:219], v[144:147], v[96:99]
    buffer_load_dwordx4 v1, s[20:23], s33 offen lds
    v_max_f32 v11, v234, v235
    v_cmp_lt_f32 vcc, s52, v11
    v_mfma_f32_16x16x32_bf16 v[100:103], v[216:219], v[148:151], v[100:103]
    s_add_u32 s34, s34, 131072
    v_add_u32 v6, s37, v4
    v_mfma_f32_16x16x32_bf16 v[108:111], v[220:223], v[148:151], v[108:111]
    buffer_load_dwordx4 v2, s[20:23], s33 offen offset:1056 lds
    s_add_u32 s35, s36, 8448
    s_cselect_b32 s35, 0xffff5b00, s35
    v_mfma_f32_16x16x32_bf16 v[104:107], v[220:223], v[144:147], v[104:107]
    s_add_u32 s33, s33, 131072
    v_add_u32 v5, s35, v3
    s_sub_u32 s41, s41, 1
    s_cbranch_vccnz L_fb1
L_fbret1:
    s_cbranch_scc0 L_ret0
L_ev0:
    s_cmp_eq_u32 s42, 1
    s_cbranch_scc1 L_evB0
    s_cmp_eq_u32 s42, 2
    s_cbranch_scc1 L_tail0
    s_mov_b64 s[20:21], s[4:5]
    s_mov_b32 s22, s18
    s_mov_b32 s33, s17
    s_mov_b32 s41, 3
    s_mov_b32 s42, 1
    s_branch L_ret0
L_evB0:
    s_mov_b64 s[20:21], s[6:7]
    s_mov_b32 s22, s18
    s_mov_b32 s26, s18
    s_mov_b32 s33, s16
    s_mov_b32 s34, s16
    s_mov_b32 s41, 0
    s_bfe_u32 s45, s15, 0x80008
    s_cmp_le_u32 s45, 16
    s_cbranch_scc1 L_retR0
    s_mov_b32 s42, 2
    s_branch L_ret0
L_ev1:
    s_cmp_eq_u32 s42, 1
    s_cbranch_scc1 L_evB1
    s_cmp_eq_u32 s42, 2
    s_cbranch_scc1 L_tail1
    s_mov_b64 s[20:21], s[4:5]
    s_mov_b32 s22, s18
    s_mov_b32 s33, s17
    s_mov_b32 s41, 3
    s_mov_b32 s42, 1
    s_branch L_ret1
L_evB1:
    s_mov_b64 s[20:21], s[6:7]
    s_mov_b32 s22, s18
    s_mov_b32 s26, s18
    s_mov_b32 s33, s16
    s_mov_b32 s34, s16
    s_mov_b32 s41, 0
    s_bfe_u32 s45, s15, 0x80008
    s_cmp_le_u32 s45, 16
    s_cbranch_scc1 L_retR1
    s_mov_b32 s42, 2
    s_branch L_ret1
L_evF:
    s_cmp_eq_u32 s42, 1
    s_cbranch_scc1 L_evBF
    s_mov_b64 s[20:21], s[4:5]
    s_mov_b32 s22, s18
    s_mov_b32 s33, s17
    s_mov_b32 s41, 3
    s_mov_b32 s42, 1
    s_branch L_retFx
L_evBF:
    s_mov_b64 s[20:21], s[6:7]
    s_mov_b32 s22, s18
    s_mov_b32 s26, s18
    s_mov_b32 s33, s16
    s_mov_b32 s34, s16
    s_mov_b32 s41, 0
    s_mov_b32 s42, 2
    s_branch L_retFx
L_evS:
    s_cmp_eq_u32 s42, 1
    s_cbranch_scc1 L_evBS
    s_mov_b64 s[20:21], s[4:5]
    s_mov_b32 s22, s18
    s_mov_b32 s33, s17
    s_mov_b32 s41, 3
    s_mov_b32 s42, 1
    s_branch L_retSx
L_evBS:
    s_mov_b64 s[20:21], s[6:7]
    s_mov_b32 s22, s18
    s_mov_b32 s26, s18
    s_mov_b32 s33, s16
    s_mov_b32 s34, s16
    s_mov_b32 s41, 0
    s_mov_b32 s42, 2
    s_branch L_retSx
L_tail0:
    s_cmp_eq_u32 s19, 0
    s_cbranch_scc1 L_tailE0
    s_add_u32 m0, s39, s38
    s_bfe_u32 s45, s15, 0x80008
    v_lshrrev_b32 v11, 4, v10
    v_lshlrev_b32 v11, 2, v11
    v_sub_u32 v11, s45, v11
    v_mov_b32 v12, 0xff800000
    s_waitcnt vmcnt(10) lgkmcnt(0)
    s_barrier
    ds_read_b64_tr_b16 v[192:193], v6 offset:0
    ds_read_b64_tr_b16 v[194:195], v6 offset:512
    v_cmp_lt_i32 s[54:55], 0, v11
    v_cmp_lt_i32 s[56:57], 1, v11
    v_cmp_lt_i32 s[58:59], 2, v11
    v_cmp_lt_i32 s[60:61], 3, v11
    v_cndmask_b32 v112, v12, v112, s[54:55]
    v_cndmask_b32 v113, v12, v113, s[56:57]
    ds_read_b64_tr_b16 v[196:197], v6 offset:32
    ds_read_b64_tr_b16 v[198:199], v6 offset:544
    v_cndmask_b32 v114, v12, v114, s[58:59]
    v_cndmask_b32 v115, v12, v115, s[60:61]
    v_cndmask_b32 v120, v12, v120, s[54:55]
    v_cndmask_b32 v121, v12, v121, s[56:57]
    v_cndmask_b32 v122, v12, v122, s[58:59]
    v_cndmask_b32 v123, v12, v123, s[60:61]
    ds_read_b64_tr_b16 v[200:201], v6 offset:64
    ds_read_b64_tr_b16 v[202:203], v6 offset:576
    v_cmp_lt_i32 s[54:55], 16, v11
    v_cmp_lt_i32 s[56:57], 17, v11
    v_cmp_lt_i32 s[58:59], 18, v11
    v_cmp_lt_i32 s[60:61], 19, v11
    v_cndmask_b32 v116, v12, v116, s[54:55]
    v_cndmask_b32 v117, v12, v117, s[56:57]
    ds_read_b64_tr_b16 v[204:205], v6 offset:96
    ds_read_b64_tr_b16 v[206:207], v6 offset:608
    v_cndmask_b32 v118, v12, v118, s[58:59]
    v_cndmask_b32 v119, v12, v119, s[60:61]
    v_cndmask_b32 v124, v12, v124, s[54:55]
    v_cndmask_b32 v125, v12, v125, s[56:57]
    v_cndmask_b32 v126, v12, v126, s[58:59]
    v_cndmask_b32 v127, v12, v127, s[60:61]
    s_waitcnt lgkmcnt(6)
    v_mfma_f32_16x16x32_bf16 v[48:51], v[192:195], v[152:155], v[48:51]
    ds_read_b64_tr_b16 v[208:209], v6 offset:128
    v_exp_f32 v236, v112
    v_mfma_f32_16x16x32_bf16 v[52:55], v[192:195], v[156:159], v[52:55]
    ds_read_b64_tr_b16 v[210:211], v6 offset:640
    v_exp_f32 v237, v113
    v_add_f32 v232, v234, v236
    s_waitcnt lgkmcnt(6)
    v_mfma_f32_16x16x32_bf16 v[60:63], v[196:199], v[156:159], v[60:63]
    ds_read_b64_tr_b16 v[212:213], v6 offset:160
    v_exp_f32 v238, v114
    v_add_f32 v232, v232, v237
    v_cvt_pk_bf16_f32 v144, v236, v237
    v_mfma_f32_16x16x32_bf16 v[56:59], v[196:199], v[152:155], v[56:59]
    ds_read_b64_tr_b16 v[214:215], v6 offset:672
    v_exp_f32 v239, v115
    v_add_f32 v232, v232, v238
    s_waitcnt lgkmcnt(6)
    v_mfma_f32_16x16x32_bf16 v[64:67], v[200:203], v[152:155], v[64:67]
    ds_read_b64_tr_b16 v[216:217], v6 offset:192
    v_exp_f32 v236, v116
    v_add_f32 v232, v232, v239
    v_cvt_pk_bf16_f32 v145, v238, v239
    v_mfma_f32_16x16x32_bf16 v[68:71], v[200:203], v[156:159], v[68:71]
    ds_read_b64_tr_b16 v[218:219], v6 offset:704
    v_exp_f32 v237, v117
    v_add_f32 v232, v232, v236
    s_waitcnt lgkmcnt(6)
    v_mfma_f32_16x16x32_bf16 v[76:79], v[204:207], v[156:159], v[76:79]
    ds_read_b64_tr_b16 v[220:221], v6 offset:224
    v_exp_f32 v238, v118
    v_add_f32 v232, v232, v237
    v_cvt_pk_bf16_f32 v146, v236, v237
    v_mfma_f32_16x16x32_bf16 v[72:75], v[204:207], v[152:155], v[72:75]
    ds_read_b64_tr_b16 v[222:223], v6 offset:736
    v_exp_f32 v239, v119
    v_add_f32 v232, v232, v238
    s_waitcnt lgkmcnt(6)
    v_mfma_f32_16x16x32_bf16 v[80:83], v[208:211], v[152:155], v[80:83]
    buffer_load_dwordx4 v1, s[24:27], s34 offen lds
    v_exp_f32 v236, v120
    v_add_f32 v232, v232, v239
    v_cvt_pk_bf16_f32 v147, v238, v239
    v_mfma_f32_16x16x32_bf16 v[84:87], v[208:211], v[156:159], v[84:87]
    s_xor_b32 s38, s38, 0x4200
    v_exp_f32 v237, v121
    v_add_f32 v233, v235, v236
    s_waitcnt lgkmcnt(4)
    v_mfma_f32_16x16x32_bf16 v[92:95], v[212:215], v[156:159], v[92:95]
    s_sub_u32 s43, s36, 8448
    v_exp_f32 v238, v122
    v_add_f32 v233, v233, v237
    v_cvt_pk_bf16_f32 v148, v236, v237
    v_mfma_f32_16x16x32_bf16 v[88:91], v[212:215], v[152:155], v[88:91]
    s_cmp_lt_u32 s43, 0xffff5b00
    v_exp_f32 v239, v123
    v_add_f32 v233, v233, v238
    s_waitcnt lgkmcnt(2)
    v_mfma_f32_16x16x32_bf16 v[96:99], v[216:219], v[152:155], v[96:99]
    s_cselect_b32 s43, 0xffffdf00, s43
    v_exp_f32 v236, v124
    v_add_f32 v233, v233, v239
    v_cvt_pk_bf16_f32 v149, v238, v239
    v_mfma_f32_16x16x32_bf16 v[100:103], v[216:219], v[156:159], v[100:103]
    buffer_load_dwordx4 v2, s[24:27], s34 offen offset:1056 lds
    v_exp_f32 v237, v125
    v_add_f32 v233, v233, v236
    s_waitcnt lgkmcnt(0)
    v_mfma_f32_16x16x32_bf16 v[108:111], v[220:223], v[156:159], v[108:111]
    s_mov_b32 s44, s37
    v_exp_f32 v238, v126
    v_add_f32 v233, v233, v237
    v_cvt_pk_bf16_f32 v150, v236, v237
    v_mfma_f32_16x16x32_bf16 v[104:107], v[220:223], v[152:155], v[104:107]
    s_add_u32 s34, s34, 131072
    v_exp_f32 v239, v127
    v_add_f32 v233, v233, v238
    v_add_u32 v6, s38, v4
    v_add_f32 v233, v233, v239
    v_cvt_pk_bf16_f32 v151, v238, v239
    v_max_f32 v11, v232, v233
    v_cmp_lt_f32 vcc, s52, v11
    s_mov_b32 s37, s38
    s_cmp_eq_u32 s19, 0
    s_cbranch_vccnz L_fbT0
L_fbretT0:
L_trans0:
    s_lshr_b32 s51, s19, 22
    s_add_u32 s51, s51, s32
    s_and_b32 s51, s51, 3
    s_add_u32 s45, s51, 1
    s_mul_i32 s45, s45, 8448
    s_add_u32 s45, s45, s43
    s_cselect_b32 s46, 0xffff5b00, 0
    s_add_u32 s45, s45, s46
    v_add_u32 v5, s45, v3
    s_cmp_ge_u32 s32, 2
    s_cselect_b32 s45, s37, s44
    s_waitcnt vmcnt(6)
    s_barrier
    ds_read_b64_tr_b16 v[192:193], v6 offset:0
    ds_read_b64_tr_b16 v[194:195], v6 offset:512
    ds_read_b64_tr_b16 v[196:197], v6 offset:32
    ds_read_b64_tr_b16 v[198:199], v6 offset:544
    ds_read_b64_tr_b16 v[200:201], v6 offset:64
    ds_read_b64_tr_b16 v[202:203], v6 offset:576
    v_permlane32_swap_b32 v232, v233
    ds_read_b128 v[160:163], v5 offset:0
    ds_read_b128 v[176:179], v5 offset:512
    v_add_f32 v232, v232, v233
    v_mov_b32 v233, v232
    ds_read_b64_tr_b16 v[204:205], v6 offset:96
    ds_read_b64_tr_b16 v[206:207], v6 offset:608
    v_permlane16_swap_b32 v232, v233
    ds_read_b64_tr_b16 v[208:209], v6 offset:128
    ds_read_b64_tr_b16 v[210:211], v6 offset:640
    v_add_f32 v232, v232, v233
    v_mov_b32 v233, v232
    ds_read_b64_tr_b16 v[212:213], v6 offset:160
    ds_read_b64_tr_b16 v[214:215], v6 offset:672
    v_permlane32_swap_b32 v232, v233
    ds_read_b64_tr_b16 v[216:217], v6 offset:192
    ds_read_b64_tr_b16 v[218:219], v6 offset:704
    s_waitcnt lgkmcnt(14)
    v_mfma_f32_16x16x32_bf16 v[48:51], v[192:195], v[144:147], v[48:51]
    ds_read_b64_tr_b16 v[220:221], v6 offset:224
    ds_read_b64_tr_b16 v[222:223], v6 offset:736
    v_rcp_f32 v245, v232
    v_rcp_f32 v246, v233
    v_mov_b32 v224, 0
    v_mov_b32 v225, 0
    v_mfma_f32_16x16x32_bf16 v[52:55], v[192:195], v[148:151], v[52:55]
    ds_read_b128 v[164:167], v5 offset:64
    ds_read_b128 v[180:183], v5 offset:576
    v_add_u32 v240, s45, v7
    v_add_u32 v244, s45, v8
    v_xor_b32 v241, 32, v240
    v_mov_b32 v226, 0
    v_mov_b32 v227, 0
    s_waitcnt lgkmcnt(15)
    v_mfma_f32_16x16x32_bf16 v[60:63], v[196:199], v[148:151], v[60:63]
    ds_read_b128 v[168:171], v5 offset:128
    ds_read_b128 v[184:187], v5 offset:640
    v_xor_b32 v242, 64, v240
    v_xor_b32 v243, 96, v240
    v_mov_b32 v228, 0
    v_mov_b32 v229, 0
    v_mov_b32 v230, 0
    v_mov_b32 v231, 0
    v_mfma_f32_16x16x32_bf16 v[56:59], v[196:199], v[144:147], v[56:59]
    ds_read_b128 v[172:175], v5 offset:192
    ds_read_b128 v[188:191], v5 offset:704
    s_waitcnt lgkmcnt(15)
    s_add_u32 s46, s3, s13
    s_mov_b32 s30, s14
    v_lshlrev_b32 v128, 16, v160
    v_and_b32 v129, 0xffff0000, v160
    v_lshlrev_b32 v130, 16, v161
    v_and_b32 v131, 0xffff0000, v161
    v_mul_f32 v128, s50, v128
    v_mul_f32 v129, s50, v129
    v_mfma_f32_16x16x32_bf16 v[64:67], v[200:203], v[144:147], v[64:67]
    v_add_u32 v5, s43, v3
    s_add_u32 s47, s46, 32768
    s_add_u32 s48, s46, 65536
    v_mul_f32 v130, s50, v130
    v_mul_f32 v131, s50, v131
    v_cvt_pk_bf16_f32 v16, v128, v129
    v_cvt_pk_bf16_f32 v17, v130, v131
    v_lshlrev_b32 v132, 16, v162
    v_and_b32 v133, 0xffff0000, v162
    v_mfma_f32_16x16x32_bf16 v[68:71], v[200:203], v[148:151], v[68:71]
    s_add_u32 s53, s46, 98304
    s_lshl_b32 s3, s51, 17
    v_lshlrev_b32 v134, 16, v163
    v_and_b32 v135, 0xffff0000, v163
    v_mul_f32 v132, s50, v132
    v_mul_f32 v133, s50, v133
    v_mul_f32 v134, s50, v134
    v_mul_f32 v135, s50, v135
    s_waitcnt lgkmcnt(14)
    v_mfma_f32_16x16x32_bf16 v[76:79], v[204:207], v[148:151], v[76:79]
    s_add_u32 s35, s43, 8448
    s_cselect_b32 s35, 0xffff5b00, s35
    v_cvt_pk_bf16_f32 v18, v132, v133
    v_cvt_pk_bf16_f32 v19, v134, v135
    v_lshlrev_b32 v136, 16, v176
    v_and_b32 v137, 0xffff0000, v176
    v_lshlrev_b32 v138, 16, v177
    v_and_b32 v139, 0xffff0000, v177
    v_mfma_f32_16x16x32_bf16 v[72:75], v[204:207], v[144:147], v[72:75]
    v_mul_f32 v136, s50, v136
    v_mul_f32 v137, s50, v137
    v_mul_f32 v138, s50, v138
    v_mul_f32 v139, s50, v139
    v_cvt_pk_bf16_f32 v32, v136, v137
    v_cvt_pk_bf16_f32 v33, v138, v139
    s_add_u32 m0, s40, s35
    v_lshlrev_b32 v140, 16, v178
    v_and_b32 v141, 0xffff0000, v178
    v_lshlrev_b32 v142, 16, v179
    v_and_b32 v143, 0xffff0000, v179
    v_mul_f32 v140, s50, v140
    v_mul_f32 v141, s50, v141
    v_mul_f32 v142, s50, v142
    v_mul_f32 v143, s50, v143
    v_cvt_pk_bf16_f32 v34, v140, v141
    v_cvt_pk_bf16_f32 v35, v142, v143
    s_waitcnt vmcnt(2) lgkmcnt(0)
    s_barrier
    v_mfma_f32_16x16x32_bf16 v[80:83], v[208:211], v[144:147], v[80:83]
    buffer_load_dwordx4 v1, s[20:23], s33 offen lds
    v_mul_f32 v48, v48, v245
    v_mul_f32 v49, v49, v245
    v_mul_f32 v50, v50, v245
    v_mul_f32 v51, v51, v245
    v_mul_f32 v52, v52, v246
    v_mul_f32 v53, v53, v246
    v_cvt_pk_bf16_f32 v48, v48, v49
    v_mfma_f32_16x16x32_bf16 v[84:87], v[208:211], v[148:151], v[84:87]
    v_cvt_pk_bf16_f32 v49, v50, v51
    v_mul_f32 v54, v54, v246
    v_mul_f32 v55, v55, v246
    ds_write_b64 v240, v[48:49] offset:0
    v_cvt_pk_bf16_f32 v52, v52, v53
    v_cvt_pk_bf16_f32 v53, v54, v55
    ds_write_b64 v240, v[52:53] offset:2048
    v_mfma_f32_16x16x32_bf16 v[92:95], v[212:215], v[148:151], v[92:95]
    buffer_load_dwordx4 v2, s[20:23], s33 offen offset:1056 lds
    v_mul_f32 v56, v56, v245
    v_mul_f32 v57, v57, v245
    v_mul_f32 v58, v58, v245
    v_mul_f32 v59, v59, v245
    v_mul_f32 v60, v60, v246
    v_mul_f32 v61, v61, v246
    v_cvt_pk_bf16_f32 v56, v56, v57
    v_mfma_f32_16x16x32_bf16 v[88:91], v[212:215], v[144:147], v[88:91]
    s_add_u32 s33, s33, 131072
    s_add_u32 s35, s35, 8448
    s_cselect_b32 s35, 0xffff5b00, s35
    s_add_u32 m0, s40, s35
    v_cvt_pk_bf16_f32 v57, v58, v59
    v_mul_f32 v62, v62, v246
    v_mul_f32 v63, v63, v246
    ds_write_b64 v241, v[56:57] offset:0
    v_cvt_pk_bf16_f32 v60, v60, v61
    v_cvt_pk_bf16_f32 v61, v62, v63
    ds_write_b64 v241, v[60:61] offset:2048
    v_mfma_f32_16x16x32_bf16 v[96:99], v[216:219], v[144:147], v[96:99]
    buffer_load_dwordx4 v1, s[20:23], s33 offen lds
    v_mul_f32 v64, v64, v245
    v_mul_f32 v65, v65, v245
    v_mul_f32 v66, v66, v245
    v_mul_f32 v67, v67, v245
    v_mul_f32 v68, v68, v246
    v_mul_f32 v69, v69, v246
    v_cvt_pk_bf16_f32 v64, v64, v65
    v_mfma_f32_16x16x32_bf16 v[100:103], v[216:219], v[148:151], v[100:103]
    v_cvt_pk_bf16_f32 v65, v66, v67
    v_mul_f32 v70, v70, v246
    v_mul_f32 v71, v71, v246
    ds_write_b64 v242, v[64:65] offset:0
    v_cvt_pk_bf16_f32 v68, v68, v69
    v_cvt_pk_bf16_f32 v69, v70, v71
    ds_write_b64 v242, v[68:69] offset:2048
    v_mfma_f32_16x16x32_bf16 v[108:111], v[220:223], v[148:151], v[108:111]
    buffer_load_dwordx4 v2, s[20:23], s33 offen offset:1056 lds
    v_mul_f32 v72, v72, v245
    v_mul_f32 v73, v73, v245
    v_mul_f32 v74, v74, v245
    v_mul_f32 v75, v75, v245
    v_mul_f32 v76, v76, v246
    v_mul_f32 v77, v77, v246
    v_cvt_pk_bf16_f32 v72, v72, v73
    v_mfma_f32_16x16x32_bf16 v[104:107], v[220:223], v[144:147], v[104:107]
    s_add_u32 s33, s33, 131072
    s_add_u32 s35, s35, 8448
    s_cselect_b32 s35, 0xffff5b00, s35
    s_add_u32 m0, s40, s35
    v_cvt_pk_bf16_f32 v73, v74, v75
    v_mul_f32 v78, v78, v246
    v_mul_f32 v79, v79, v246
    ds_write_b64 v243, v[72:73] offset:0
    v_cvt_pk_bf16_f32 v76, v76, v77
    v_cvt_pk_bf16_f32 v77, v78, v79
    ds_write_b64 v243, v[76:77] offset:2048
    ds_read_b128 v[48:51], v244 offset:0
    ds_read_b64 v[52:53], v244 offset:1032
    ds_read_b64 v[54:55], v244 offset:1024
    ds_read_b128 v[56:59], v244 offset:2048
    ds_read_b64 v[60:61], v244 offset:3080
    ds_read_b64 v[62:63], v244 offset:3072
    ds_read_b128 v[192:195], v5 offset:0
    ds_read_b128 v[208:211], v5 offset:512
    ds_read_b128 v[196:199], v5 offset:64
    ds_read_b128 v[212:215], v5 offset:576
    ds_read_b128 v[200:203], v5 offset:128
    ds_read_b128 v[216:219], v5 offset:640
    ds_read_b128 v[204:207], v5 offset:192
    ds_read_b128 v[220:223], v5 offset:704
    v_mul_f32 v80, v80, v245
    v_mul_f32 v81, v81, v245
    v_mul_f32 v82, v82, v245
    v_mul_f32 v83, v83, v245
    v_mul_f32 v84, v84, v246
    v_mul_f32 v85, v85, v246
    v_cvt_pk_bf16_f32 v80, v80, v81
    v_cvt_pk_bf16_f32 v81, v82, v83
    v_mul_f32 v86, v86, v246
    v_mul_f32 v87, v87, v246
    s_waitcnt lgkmcnt(13)
    buffer_store_dwordx4 v[48:51], v9, s[28:31], s46 offen offset:0 nt
    ds_write_b64 v240, v[80:81] offset:0
    v_cvt_pk_bf16_f32 v84, v84, v85
    v_cvt_pk_bf16_f32 v85, v86, v87
    ds_write_b64 v240, v[84:85] offset:2048
    v_mul_f32 v88, v88, v245
    v_mul_f32 v89, v89, v245
    v_mul_f32 v90, v90, v245
    v_mul_f32 v91, v91, v245
    v_mul_f32 v92, v92, v246
    v_mul_f32 v93, v93, v246
    v_cvt_pk_bf16_f32 v88, v88, v89
    v_cvt_pk_bf16_f32 v89, v90, v91
    s_waitcnt lgkmcnt(13)
    buffer_store_dwordx4 v[52:55], v9, s[28:31], s47 offen offset:0 nt
    v_mul_f32 v94, v94, v246
    v_mul_f32 v95, v95, v246
    ds_write_b64 v241, v[88:89] offset:0
    v_cvt_pk_bf16_f32 v92, v92, v93
    v_cvt_pk_bf16_f32 v93, v94, v95
    ds_write_b64 v241, v[92:93] offset:2048
    v_mul_f32 v96, v96, v245
    v_mul_f32 v97, v97, v245
    v_mul_f32 v98, v98, v245
    v_mul_f32 v99, v99, v245
    v_mul_f32 v100, v100, v246
    v_mul_f32 v101, v101, v246
    s_waitcnt lgkmcnt(14)
    buffer_store_dwordx4 v[56:59], v9, s[28:31], s48 offen offset:0 nt
    v_cvt_pk_bf16_f32 v96, v96, v97
    v_cvt_pk_bf16_f32 v97, v98, v99
    v_mul_f32 v102, v102, v246
    v_mul_f32 v103, v103, v246
    ds_write_b64 v242, v[96:97] offset:0
    v_cvt_pk_bf16_f32 v100, v100, v101
    v_cvt_pk_bf16_f32 v101, v102, v103
    ds_write_b64 v242, v[100:101] offset:2048
    v_mul_f32 v104, v104, v245
    v_mul_f32 v105, v105, v245
    v_mul_f32 v106, v106, v245
    v_mul_f32 v107, v107, v245
    s_waitcnt lgkmcnt(14)
    buffer_store_dwordx4 v[60:63], v9, s[28:31], s53 offen offset:0 nt
    v_mul_f32 v108, v108, v246
    v_mul_f32 v109, v109, v246
    v_cvt_pk_bf16_f32 v104, v104, v105
    v_cvt_pk_bf16_f32 v105, v106, v107
    v_mul_f32 v110, v110, v246
    v_mul_f32 v111, v111, v246
    ds_write_b64 v243, v[104:105] offset:0
    v_cvt_pk_bf16_f32 v108, v108, v109
    v_cvt_pk_bf16_f32 v109, v110, v111
    ds_write_b64 v243, v[108:109] offset:2048
    ds_read_b128 v[80:83], v244 offset:0
    ds_read_b64 v[84:85], v244 offset:1032
    ds_read_b64 v[86:87], v244 offset:1024
    ds_read_b128 v[88:91], v244 offset:2048
    ds_read_b64 v[92:93], v244 offset:3080
    ds_read_b64 v[94:95], v244 offset:3072
    s_nop 1
    s_waitcnt lgkmcnt(15)
    v_mfma_f32_16x16x32_bf16 v[112:115], v[192:195], v[16:19], v[224:227]
    buffer_load_dwordx4 v1, s[20:23], s33 offen lds
    v_lshlrev_b32 v128, 16, v164
    v_and_b32 v129, 0xffff0000, v164
    v_lshlrev_b32 v130, 16, v165
    v_and_b32 v131, 0xffff0000, v165
    v_mul_f32 v128, s50, v128
    v_mul_f32 v129, s50, v129
    v_mul_f32 v130, s50, v130
    v_mul_f32 v131, s50, v131
    v_cvt_pk_bf16_f32 v20, v128, v129
    v_cvt_pk_bf16_f32 v21, v130, v131
    v_mfma_f32_16x16x32_bf16 v[120:123], v[192:195], v[32:35], v[228:231]
    v_lshlrev_b32 v132, 16, v166
    v_and_b32 v133, 0xffff0000, v166
    v_lshlrev_b32 v134, 16, v167
    v_and_b32 v135, 0xffff0000, v167
    v_mul_f32 v132, s50, v132
    v_mul_f32 v133, s50, v133
    v_mul_f32 v134, s50, v134
    v_mul_f32 v135, s50, v135
    v_cvt_pk_bf16_f32 v22, v132, v133
    v_cvt_pk_bf16_f32 v23, v134, v135
    v_mfma_f32_16x16x32_bf16 v[124:127], v[208:211], v[32:35], v[228:231]
    buffer_load_dwordx4 v2, s[20:23], s33 offen offset:1056 lds
    v_lshlrev_b32 v136, 16, v180
    v_and_b32 v137, 0xffff0000, v180
    v_lshlrev_b32 v138, 16, v181
    v_and_b32 v139, 0xffff0000, v181
    v_mul_f32 v136, s50, v136
    v_mul_f32 v137, s50, v137
    v_mul_f32 v138, s50, v138
    v_mul_f32 v139, s50, v139
    v_cvt_pk_bf16_f32 v36, v136, v137
    v_cvt_pk_bf16_f32 v37, v138, v139
    v_mfma_f32_16x16x32_bf16 v[116:119], v[208:211], v[16:19], v[224:227]
    s_add_u32 s33, s33, 131072
    s_add_u32 s35, s35, 8448
    s_cselect_b32 s35, 0xffff5b00, s35
    s_add_u32 m0, s40, s35
    v_lshlrev_b32 v140, 16, v182
    v_and_b32 v141, 0xffff0000, v182
    v_lshlrev_b32 v142, 16, v183
    v_and_b32 v143, 0xffff0000, v183
    v_mul_f32 v140, s50, v140
    v_mul_f32 v141, s50, v141
    v_mul_f32 v142, s50, v142
    v_mul_f32 v143, s50, v143
    v_cvt_pk_bf16_f32 v38, v140, v141
    v_cvt_pk_bf16_f32 v39, v142, v143
    s_nop 1
    v_mfma_f32_16x16x32_bf16 v[112:115], v[196:199], v[20:23], v[112:115]
    s_waitcnt lgkmcnt(5)
    buffer_store_dwordx4 v[80:83], v9, s[28:31], s46 offen offset:128 nt
    v_lshlrev_b32 v128, 16, v168
    v_and_b32 v129, 0xffff0000, v168
    v_lshlrev_b32 v130, 16, v169
    v_and_b32 v131, 0xffff0000, v169
    v_mul_f32 v128, s50, v128
    v_mul_f32 v129, s50, v129
    v_mul_f32 v130, s50, v130
    v_mul_f32 v131, s50, v131
    v_cvt_pk_bf16_f32 v24, v128, v129
    v_cvt_pk_bf16_f32 v25, v130, v131
    v_mfma_f32_16x16x32_bf16 v[120:123], v[196:199], v[36:39], v[120:123]
    v_lshlrev_b32 v132, 16, v170
    v_and_b32 v133, 0xffff0000, v170
    v_lshlrev_b32 v134, 16, v171
    v_and_b32 v135, 0xffff0000, v171
    v_mul_f32 v132, s50, v132
    v_mul_f32 v133, s50, v133
    v_mul_f32 v134, s50, v134
    v_mul_f32 v135, s50, v135
    v_cvt_pk_bf16_f32 v26, v132, v133
    v_cvt_pk_bf16_f32 v27, v134, v135
    v_mfma_f32_16x16x32_bf16 v[124:127], v[212:215], v[36:39], v[124:127]
    s_waitcnt lgkmcnt(3)
    buffer_store_dwordx4 v[84:87], v9, s[28:31], s47 offen offset:128 nt
    v_lshlrev_b32 v136, 16, v184
    v_and_b32 v137, 0xffff0000, v184
    v_lshlrev_b32 v138, 16, v185
    v_and_b32 v139, 0xffff0000, v185
    v_mul_f32 v136, s50, v136
    v_mul_f32 v137, s50, v137
    v_mul_f32 v138, s50, v138
    v_mul_f32 v139, s50, v139
    v_cvt_pk_bf16_f32 v40, v136, v137
    v_cvt_pk_bf16_f32 v41, v138, v139
    v_mfma_f32_16x16x32_bf16 v[116:119], v[212:215], v[20:23], v[116:119]
    v_lshlrev_b32 v140, 16, v186
    v_and_b32 v141, 0xffff0000, v186
    v_lshlrev_b32 v142, 16, v187
    v_and_b32 v143, 0xffff0000, v187
    v_mul_f32 v140, s50, v140
    v_mul_f32 v141, s50, v141
    v_mul_f32 v142, s50, v142
    v_mul_f32 v143, s50, v143
    v_cvt_pk_bf16_f32 v42, v140, v141
    v_cvt_pk_bf16_f32 v43, v142, v143
    s_nop 1
    v_mfma_f32_16x16x32_bf16 v[112:115], v[200:203], v[24:27], v[112:115]
    s_waitcnt lgkmcnt(2)
    buffer_store_dwordx4 v[88:91], v9, s[28:31], s48 offen offset:128 nt
    v_lshlrev_b32 v128, 16, v172
    v_and_b32 v129, 0xffff0000, v172
    v_lshlrev_b32 v130, 16, v173
    v_and_b32 v131, 0xffff0000, v173
    v_mul_f32 v128, s50, v128
    v_mul_f32 v129, s50, v129
    v_mul_f32 v130, s50, v130
    v_mul_f32 v131, s50, v131
    v_cvt_pk_bf16_f32 v28, v128, v129
    v_cvt_pk_bf16_f32 v29, v130, v131
    v_mfma_f32_16x16x32_bf16 v[120:123], v[200:203], v[40:43], v[120:123]
    v_lshlrev_b32 v132, 16, v174
    v_and_b32 v133, 0xffff0000, v174
    v_lshlrev_b32 v134, 16, v175
    v_and_b32 v135, 0xffff0000, v175
    v_mul_f32 v132, s50, v132
    v_mul_f32 v133, s50, v133
    v_mul_f32 v134, s50, v134
    v_mul_f32 v135, s50, v135
    v_cvt_pk_bf16_f32 v30, v132, v133
    v_cvt_pk_bf16_f32 v31, v134, v135
    v_mfma_f32_16x16x32_bf16 v[124:127], v[216:219], v[40:43], v[124:127]
    s_waitcnt lgkmcnt(0)
    buffer_store_dwordx4 v[92:95], v9, s[28:31], s53 offen offset:128 nt
    v_lshlrev_b32 v136, 16, v188
    v_and_b32 v137, 0xffff0000, v188
    v_lshlrev_b32 v138, 16, v189
    v_and_b32 v139, 0xffff0000, v189
    v_mul_f32 v136, s50, v136
    v_mul_f32 v137, s50, v137
    v_mul_f32 v138, s50, v138
    v_mul_f32 v139, s50, v139
    v_cvt_pk_bf16_f32 v44, v136, v137
    v_cvt_pk_bf16_f32 v45, v138, v139
    v_mfma_f32_16x16x32_bf16 v[116:119], v[216:219], v[24:27], v[116:119]
    v_lshlrev_b32 v140, 16, v190
    v_and_b32 v141, 0xffff0000, v190
    v_lshlrev_b32 v142, 16, v191
    v_and_b32 v143, 0xffff0000, v191
    v_mul_f32 v140, s50, v140
    v_mul_f32 v141, s50, v141
    v_mul_f32 v142, s50, v142
    v_mul_f32 v143, s50, v143
    v_cvt_pk_bf16_f32 v46, v140, v141
    v_cvt_pk_bf16_f32 v47, v142, v143
    s_nop 1
    v_mfma_f32_16x16x32_bf16 v[112:115], v[204:207], v[28:31], v[112:115]
    buffer_load_dwordx4 v1, s[20:23], s33 offen lds
    s_mov_b64 s[12:13], s[16:17]
    s_mov_b64 s[14:15], s[18:19]
    v_mfma_f32_16x16x32_bf16 v[120:123], v[204:207], v[44:47], v[120:123]
    s_mov_b64 s[16:17], 0
    s_mov_b64 s[18:19], 0
    s_mov_b32 s62, 0
    v_mfma_f32_16x16x32_bf16 v[124:127], v[220:223], v[44:47], v[124:127]
    v_mfma_f32_16x16x32_bf16 v[116:119], v[220:223], v[28:31], v[116:119]
    buffer_load_dwordx4 v2, s[20:23], s33 offen offset:1056 lds
    s_add_u32 s33, s33, 131072
    s_waitcnt vmcnt(12)
    s_branch L_pre0
L_tailE0:
    s_xor_b32 s46, s38, 0x4200
    s_bfe_u32 s45, s15, 0x80008
    v_lshrrev_b32 v11, 4, v10
    v_lshlrev_b32 v11, 2, v11
    v_sub_u32 v11, s45, v11
    v_mov_b32 v12, 0xff800000
    v_add_u32 v247, s46, v4
    s_waitcnt vmcnt(6) lgkmcnt(0)
    s_barrier
    ds_read_b64_tr_b16 v[192:193], v6 offset:0
    ds_read_b64_tr_b16 v[194:195], v6 offset:512
    v_cmp_lt_i32 s[54:55], 0, v11
    v_cmp_lt_i32 s[56:57], 1, v11
    v_cmp_lt_i32 s[58:59], 2, v11
    v_cmp_lt_i32 s[60:61], 3, v11
    v_cndmask_b32 v112, v12, v112, s[54:55]
    v_cndmask_b32 v113, v12, v113, s[56:57]
    ds_read_b64_tr_b16 v[196:197], v6 offset:32
    ds_read_b64_tr_b16 v[198:199], v6 offset:544
    v_cndmask_b32 v114, v12, v114, s[58:59]
    v_cndmask_b32 v115, v12, v115, s[60:61]
    v_cndmask_b32 v120, v12, v120, s[54:55]
    v_cndmask_b32 v121, v12, v121, s[56:57]
    v_cndmask_b32 v122, v12, v122, s[58:59]
    v_cndmask_b32 v123, v12, v123, s[60:61]
    ds_read_b64_tr_b16 v[200:201], v6 offset:64
    ds_read_b64_tr_b16 v[202:203], v6 offset:576
    v_cmp_lt_i32 s[54:55], 16, v11
    v_cmp_lt_i32 s[56:57], 17, v11
    v_cmp_lt_i32 s[58:59], 18, v11
    v_cmp_lt_i32 s[60:61], 19, v11
    v_cndmask_b32 v116, v12, v116, s[54:55]
    v_cndmask_b32 v117, v12, v117, s[56:57]
    ds_read_b64_tr_b16 v[204:205], v6 offset:96
    ds_read_b64_tr_b16 v[206:207], v6 offset:608
    v_cndmask_b32 v118, v12, v118, s[58:59]
    v_cndmask_b32 v119, v12, v119, s[60:61]
    v_cndmask_b32 v124, v12, v124, s[54:55]
    v_cndmask_b32 v125, v12, v125, s[56:57]
    v_cndmask_b32 v126, v12, v126, s[58:59]
    v_cndmask_b32 v127, v12, v127, s[60:61]
    s_waitcnt lgkmcnt(6)
    v_mfma_f32_16x16x32_bf16 v[48:51], v[192:195], v[152:155], v[48:51]
    v_exp_f32 v236, v112
    ds_read_b64_tr_b16 v[208:209], v6 offset:128
    s_add_u32 s43, s35, 8448
    s_cselect_b32 s43, 0xffff5b00, s43
    v_mfma_f32_16x16x32_bf16 v[52:55], v[192:195], v[156:159], v[52:55]
    v_exp_f32 v237, v113
    ds_read_b64_tr_b16 v[210:211], v6 offset:640
    s_cmp_eq_u32 s32, 1
    s_cselect_b32 s43, s35, s43
    v_add_f32 v232, v234, v236
    s_waitcnt lgkmcnt(6)
    v_mfma_f32_16x16x32_bf16 v[60:63], v[196:199], v[156:159], v[60:63]
    v_exp_f32 v238, v114
    ds_read_b64_tr_b16 v[212:213], v6 offset:160
    s_cmp_eq_u32 s32, 0
    s_cselect_b32 s43, s36, s43
    v_add_f32 v232, v232, v237
    v_cvt_pk_bf16_f32 v144, v236, v237
    v_mfma_f32_16x16x32_bf16 v[56:59], v[196:199], v[152:155], v[56:59]
    v_exp_f32 v239, v115
    ds_read_b64_tr_b16 v[214:215], v6 offset:672
    s_add_u32 s43, s43, 76032
    s_cmp_eq_u32 s32, 3
    v_add_f32 v232, v232, v238
    s_waitcnt lgkmcnt(6)
    v_mfma_f32_16x16x32_bf16 v[64:67], v[200:203], v[152:155], v[64:67]
    v_exp_f32 v236, v116
    ds_read_b64_tr_b16 v[216:217], v6 offset:192
    s_cselect_b32 s43, s38, s43
    s_and_b32 s45, s32, 1
    v_add_f32 v232, v232, v239
    v_cvt_pk_bf16_f32 v145, v238, v239
    v_mfma_f32_16x16x32_bf16 v[68:71], v[200:203], v[156:159], v[68:71]
    v_exp_f32 v237, v117
    ds_read_b64_tr_b16 v[218:219], v6 offset:704
    s_lshl_b32 s45, s45, 12
    s_sub_u32 s45, s43, s45
    v_add_f32 v232, v232, v236
    s_waitcnt lgkmcnt(6)
    v_mfma_f32_16x16x32_bf16 v[76:79], v[204:207], v[156:159], v[76:79]
    v_exp_f32 v238, v118
    ds_read_b64_tr_b16 v[220:221], v6 offset:224
    s_add_u32 s46, s3, s13
    s_mov_b32 s30, s14
    v_add_f32 v232, v232, v237
    v_cvt_pk_bf16_f32 v146, v236, v237
    v_mfma_f32_16x16x32_bf16 v[72:75], v[204:207], v[152:155], v[72:75]
    v_exp_f32 v239, v119
    ds_read_b64_tr_b16 v[222:223], v6 offset:736
    s_add_u32 s47, s46, 32768
    s_add_u32 s48, s46, 65536
    v_add_f32 v232, v232, v238
    s_waitcnt lgkmcnt(6)
    v_mfma_f32_16x16x32_bf16 v[80:83], v[208:211], v[152:155], v[80:83]
    v_exp_f32 v236, v120
    ds_read_b64_tr_b16 v[160:161], v247 offset:0
    ds_read_b64_tr_b16 v[162:163], v247 offset:512
    s_add_u32 s53, s46, 98304
    v_add_f32 v232, v232, v239
    v_cvt_pk_bf16_f32 v147, v238, v239
    v_mfma_f32_16x16x32_bf16 v[84:87], v[208:211], v[156:159], v[84:87]
    v_exp_f32 v237, v121
    ds_read_b64_tr_b16 v[164:165], v247 offset:32
    ds_read_b64_tr_b16 v[166:167], v247 offset:544
    v_add_f32 v233, v235, v236
    v_add_u32 v240, s45, v7
    s_waitcnt lgkmcnt(8)
    v_mfma_f32_16x16x32_bf16 v[92:95], v[212:215], v[156:159], v[92:95]
    v_exp_f32 v238, v122
    ds_read_b64_tr_b16 v[168:169], v247 offset:64
    ds_read_b64_tr_b16 v[170:171], v247 offset:576
    v_add_f32 v233, v233, v237
    v_cvt_pk_bf16_f32 v148, v236, v237
    v_mfma_f32_16x16x32_bf16 v[88:91], v[212:215], v[152:155], v[88:91]
    v_exp_f32 v239, v123
    ds_read_b64_tr_b16 v[172:173], v247 offset:96
    ds_read_b64_tr_b16 v[174:175], v247 offset:608
    v_add_f32 v233, v233, v238
    v_add_u32 v244, s45, v8
    s_waitcnt lgkmcnt(10)
    v_mfma_f32_16x16x32_bf16 v[96:99], v[216:219], v[152:155], v[96:99]
    v_exp_f32 v236, v124
    ds_read_b64_tr_b16 v[176:177], v247 offset:128
    ds_read_b64_tr_b16 v[178:179], v247 offset:640
    v_add_f32 v233, v233, v239
    v_cvt_pk_bf16_f32 v149, v238, v239
    v_mfma_f32_16x16x32_bf16 v[100:103], v[216:219], v[156:159], v[100:103]
    v_exp_f32 v237, v125
    ds_read_b64_tr_b16 v[180:181], v247 offset:160
    ds_read_b64_tr_b16 v[182:183], v247 offset:672
    v_add_f32 v233, v233, v236
    v_xor_b32 v241, 32, v240
    s_waitcnt lgkmcnt(12)
    v_mfma_f32_16x16x32_bf16 v[108:111], v[220:223], v[156:159], v[108:111]
    v_exp_f32 v238, v126
    ds_read_b64_tr_b16 v[184:185], v247 offset:192
    ds_read_b64_tr_b16 v[186:187], v247 offset:704
    v_add_f32 v233, v233, v237
    v_cvt_pk_bf16_f32 v150, v236, v237
    v_mfma_f32_16x16x32_bf16 v[104:107], v[220:223], v[152:155], v[104:107]
    v_exp_f32 v239, v127
    ds_read_b64_tr_b16 v[188:189], v247 offset:224
    ds_read_b64_tr_b16 v[190:191], v247 offset:736
    v_add_f32 v233, v233, v238
    v_xor_b32 v242, 64, v240
    v_xor_b32 v243, 96, v240
    v_add_f32 v233, v233, v239
    v_cvt_pk_bf16_f32 v151, v238, v239
    v_max_f32 v11, v232, v233
    v_cmp_lt_f32 vcc, s52, v11
    s_cmp_eq_u32 s19, 0
    s_cbranch_vccnz L_fbT0
L_fbretE0:
    s_setprio 0
    s_waitcnt lgkmcnt(14)
    v_mfma_f32_16x16x32_bf16 v[48:51], v[160:163], v[144:147], v[48:51]
    v_permlane32_swap_b32 v232, v233
    v_add_f32 v232, v232, v233
    v_mov_b32 v233, v232
    s_waitcnt lgkmcnt(12)
    v_mfma_f32_16x16x32_bf16 v[56:59], v[164:167], v[144:147], v[56:59]
    s_nop 0
    v_permlane16_swap_b32 v232, v233
    v_add_f32 v232, v232, v233
    v_mov_b32 v233, v232
    s_waitcnt lgkmcnt(10)
    v_mfma_f32_16x16x32_bf16 v[64:67], v[168:171], v[144:147], v[64:67]
    s_nop 0
    v_permlane32_swap_b32 v232, v233
    v_rcp_f32 v245, v232
    s_waitcnt lgkmcnt(8)
    v_mfma_f32_16x16x32_bf16 v[72:75], v[172:175], v[144:147], v[72:75]
    v_rcp_f32 v246, v233
    v_mfma_f32_16x16x32_bf16 v[52:55], v[160:163], v[148:151], v[52:55]
    v_mul_f32 v48, v48, v245
    v_mul_f32 v49, v49, v245
    v_mul_f32 v50, v50, v245
    v_mfma_f32_16x16x32_bf16 v[60:63], v[164:167], v[148:151], v[60:63]
    v_mul_f32 v51, v51, v245
    v_cvt_pk_bf16_f32 v48, v48, v49
    v_cvt_pk_bf16_f32 v49, v50, v51
    ds_write_b64 v240, v[48:49] offset:0
    v_mfma_f32_16x16x32_bf16 v[68:71], v[168:171], v[148:151], v[68:71]
    v_mul_f32 v56, v56, v245
    v_mul_f32 v57, v57, v245
    v_mul_f32 v58, v58, v245
    v_mul_f32 v59, v59, v245
    v_mfma_f32_16x16x32_bf16 v[76:79], v[172:175], v[148:151], v[76:79]
    v_cvt_pk_bf16_f32 v56, v56, v57
    v_cvt_pk_bf16_f32 v57, v58, v59
    ds_write_b64 v241, v[56:57] offset:0
    v_mul_f32 v64, v64, v245
    s_waitcnt lgkmcnt(8)
    v_mfma_f32_16x16x32_bf16 v[80:83], v[176:179], v[144:147], v[80:83]
    v_mul_f32 v65, v65, v245
    v_mul_f32 v66, v66, v245
    v_mul_f32 v67, v67, v245
    v_cvt_pk_bf16_f32 v64, v64, v65
    s_waitcnt lgkmcnt(6)
    v_mfma_f32_16x16x32_bf16 v[88:91], v[180:183], v[144:147], v[88:91]
    v_cvt_pk_bf16_f32 v65, v66, v67
    ds_write_b64 v242, v[64:65] offset:0
    v_mul_f32 v72, v72, v245
    v_mul_f32 v73, v73, v245
    s_waitcnt lgkmcnt(5)
    v_mfma_f32_16x16x32_bf16 v[96:99], v[184:187], v[144:147], v[96:99]
    v_mul_f32 v74, v74, v245
    v_mul_f32 v75, v75, v245
    v_cvt_pk_bf16_f32 v72, v72, v73
    v_cvt_pk_bf16_f32 v73, v74, v75
    s_waitcnt lgkmcnt(3)
    v_mfma_f32_16x16x32_bf16 v[104:107], v[188:191], v[144:147], v[104:107]
    ds_write_b64 v243, v[72:73] offset:0
    ds_read_b128 v[112:115], v244 offset:0
    ds_read_b64 v[116:117], v244 offset:1032
    ds_read_b64 v[118:119], v244 offset:1024
    v_mul_f32 v52, v52, v246
    v_mul_f32 v53, v53, v246
    v_mul_f32 v54, v54, v246
    v_mfma_f32_16x16x32_bf16 v[84:87], v[176:179], v[148:151], v[84:87]
    v_mul_f32 v55, v55, v246
    v_cvt_pk_bf16_f32 v52, v52, v53
    v_cvt_pk_bf16_f32 v53, v54, v55
    ds_write_b64 v240, v[52:53] offset:2048
    v_mfma_f32_16x16x32_bf16 v[92:95], v[180:183], v[148:151], v[92:95]
    v_mul_f32 v60, v60, v246
    v_mul_f32 v61, v61, v246
    v_mul_f32 v62, v62, v246
    v_mul_f32 v63, v63, v246
    v_mfma_f32_16x16x32_bf16 v[100:103], v[184:187], v[148:151], v[100:103]
    v_cvt_pk_bf16_f32 v60, v60, v61
    v_cvt_pk_bf16_f32 v61, v62, v63
    ds_write_b64 v241, v[60:61] offset:2048
    v_mul_f32 v68, v68, v246
    v_mfma_f32_16x16x32_bf16 v[108:111], v[188:191], v[148:151], v[108:111]
    v_mul_f32 v69, v69, v246
    v_mul_f32 v70, v70, v246
    v_mul_f32 v71, v71, v246
    s_waitcnt lgkmcnt(4)
    buffer_store_dwordx4 v[112:115], v9, s[28:31], s46 offen offset:0 nt
    v_cvt_pk_bf16_f32 v68, v68, v69
    v_cvt_pk_bf16_f32 v69, v70, v71
    ds_write_b64 v242, v[68:69] offset:2048
    v_mul_f32 v76, v76, v246
    v_mul_f32 v77, v77, v246
    v_mul_f32 v78, v78, v246
    s_waitcnt lgkmcnt(3)
    buffer_store_dwordx4 v[116:119], v9, s[28:31], s47 offen offset:0 nt
    v_mul_f32 v79, v79, v246
    v_cvt_pk_bf16_f32 v76, v76, v77
    v_cvt_pk_bf16_f32 v77, v78, v79
    ds_write_b64 v243, v[76:77] offset:2048
    ds_read_b128 v[120:123], v244 offset:2048
    ds_read_b64 v[124:125], v244 offset:3080
    ds_read_b64 v[126:127], v244 offset:3072
    v_mul_f32 v80, v80, v245
    v_mul_f32 v81, v81, v245
    v_mul_f32 v82, v82, v245
    v_mul_f32 v83, v83, v245
    v_cvt_pk_bf16_f32 v80, v80, v81
    v_cvt_pk_bf16_f32 v81, v82, v83
    ds_write_b64 v240, v[80:81] offset:4096
    v_mul_f32 v88, v88, v245
    v_mul_f32 v89, v89, v245
    v_mul_f32 v90, v90, v245
    v_mul_f32 v91, v91, v245
    v_cvt_pk_bf16_f32 v88, v88, v89
    v_cvt_pk_bf16_f32 v89, v90, v91
    ds_write_b64 v241, v[88:89] offset:4096
    v_mul_f32 v96, v96, v245
    v_mul_f32 v97, v97, v245
    v_mul_f32 v98, v98, v245
    v_mul_f32 v99, v99, v245
    s_waitcnt lgkmcnt(4)
    buffer_store_dwordx4 v[120:123], v9, s[28:31], s48 offen offset:0 nt
    v_cvt_pk_bf16_f32 v96, v96, v97
    v_cvt_pk_bf16_f32 v97, v98, v99
    ds_write_b64 v242, v[96:97] offset:4096
    v_mul_f32 v104, v104, v245
    v_mul_f32 v105, v105, v245
    v_mul_f32 v106, v106, v245
    s_waitcnt lgkmcnt(3)
    buffer_store_dwordx4 v[124:127], v9, s[28:31], s53 offen offset:0 nt
    v_mul_f32 v107, v107, v245
    v_cvt_pk_bf16_f32 v104, v104, v105
    v_cvt_pk_bf16_f32 v105, v106, v107
    ds_write_b64 v243, v[104:105] offset:4096
    ds_read_b128 v[128:131], v244 offset:4096
    ds_read_b64 v[132:133], v244 offset:5128
    ds_read_b64 v[134:135], v244 offset:5120
    v_mul_f32 v84, v84, v246
    v_mul_f32 v85, v85, v246
    v_mul_f32 v86, v86, v246
    v_mul_f32 v87, v87, v246
    v_cvt_pk_bf16_f32 v84, v84, v85
    v_cvt_pk_bf16_f32 v85, v86, v87
    ds_write_b64 v240, v[84:85] offset:6144
    v_mul_f32 v92, v92, v246
    v_mul_f32 v93, v93, v246
    v_mul_f32 v94, v94, v246
    v_mul_f32 v95, v95, v246
    v_cvt_pk_bf16_f32 v92, v92, v93
    v_cvt_pk_bf16_f32 v93, v94, v95
    ds_write_b64 v241, v[92:93] offset:6144
    v_mul_f32 v100, v100, v246
    v_mul_f32 v101, v101, v246
    v_mul_f32 v102, v102, v246
    v_mul_f32 v103, v103, v246
    s_waitcnt lgkmcnt(4)
    buffer_store_dwordx4 v[128:131], v9, s[28:31], s46 offen offset:128 nt
    v_cvt_pk_bf16_f32 v100, v100, v101
    v_cvt_pk_bf16_f32 v101, v102, v103
    ds_write_b64 v242, v[100:101] offset:6144
    v_mul_f32 v108, v108, v246
    v_mul_f32 v109, v109, v246
    v_mul_f32 v110, v110, v246
    s_waitcnt lgkmcnt(3)
    buffer_store_dwordx4 v[132:135], v9, s[28:31], s47 offen offset:128 nt
    v_mul_f32 v111, v111, v246
    v_cvt_pk_bf16_f32 v108, v108, v109
    v_cvt_pk_bf16_f32 v109, v110, v111
    ds_write_b64 v243, v[108:109] offset:6144
    ds_read_b128 v[136:139], v244 offset:6144
    ds_read_b64 v[140:141], v244 offset:7176
    ds_read_b64 v[142:143], v244 offset:7168
    s_waitcnt lgkmcnt(2)
    buffer_store_dwordx4 v[136:139], v9, s[28:31], s48 offen offset:128 nt
    s_waitcnt lgkmcnt(0)
    buffer_store_dwordx4 v[140:143], v9, s[28:31], s53 offen offset:128 nt
    s_branch L_fin
L_tail1:
    s_cmp_eq_u32 s19, 0
    s_cbranch_scc1 L_tailE1
    s_add_u32 m0, s39, s37
    s_bfe_u32 s45, s15, 0x80008
    v_lshrrev_b32 v11, 4, v10
    v_lshlrev_b32 v11, 2, v11
    v_sub_u32 v11, s45, v11
    v_mov_b32 v12, 0xff800000
    s_waitcnt vmcnt(10) lgkmcnt(0)
    s_barrier
    ds_read_b64_tr_b16 v[192:193], v6 offset:0
    ds_read_b64_tr_b16 v[194:195], v6 offset:512
    v_cmp_lt_i32 s[54:55], 0, v11
    v_cmp_lt_i32 s[56:57], 1, v11
    v_cmp_lt_i32 s[58:59], 2, v11
    v_cmp_lt_i32 s[60:61], 3, v11
    v_cndmask_b32 v128, v12, v128, s[54:55]
    v_cndmask_b32 v129, v12, v129, s[56:57]
    ds_read_b64_tr_b16 v[196:197], v6 offset:32
    ds_read_b64_tr_b16 v[198:199], v6 offset:544
    v_cndmask_b32 v130, v12, v130, s[58:59]
    v_cndmask_b32 v131, v12, v131, s[60:61]
    v_cndmask_b32 v136, v12, v136, s[54:55]
    v_cndmask_b32 v137, v12, v137, s[56:57]
    v_cndmask_b32 v138, v12, v138, s[58:59]
    v_cndmask_b32 v139, v12, v139, s[60:61]
    ds_read_b64_tr_b16 v[200:201], v6 offset:64
    ds_read_b64_tr_b16 v[202:203], v6 offset:576
    v_cmp_lt_i32 s[54:55], 16, v11
    v_cmp_lt_i32 s[56:57], 17, v11
    v_cmp_lt_i32 s[58:59], 18, v11
    v_cmp_lt_i32 s[60:61], 19, v11
    v_cndmask_b32 v132, v12, v132, s[54:55]
    v_cndmask_b32 v133, v12, v133, s[56:57]
    ds_read_b64_tr_b16 v[204:205], v6 offset:96
    ds_read_b64_tr_b16 v[206:207], v6 offset:608
    v_cndmask_b32 v134, v12, v134, s[58:59]
    v_cndmask_b32 v135, v12, v135, s[60:61]
    v_cndmask_b32 v140, v12, v140, s[54:55]
    v_cndmask_b32 v141, v12, v141, s[56:57]
    v_cndmask_b32 v142, v12, v142, s[58:59]
    v_cndmask_b32 v143, v12, v143, s[60:61]
    s_waitcnt lgkmcnt(6)
    v_mfma_f32_16x16x32_bf16 v[48:51], v[192:195], v[144:147], v[48:51]
    ds_read_b64_tr_b16 v[208:209], v6 offset:128
    v_exp_f32 v236, v128
    v_mfma_f32_16x16x32_bf16 v[52:55], v[192:195], v[148:151], v[52:55]
    ds_read_b64_tr_b16 v[210:211], v6 offset:640
    v_exp_f32 v237, v129
    v_add_f32 v234, v232, v236
    s_waitcnt lgkmcnt(6)
    v_mfma_f32_16x16x32_bf16 v[60:63], v[196:199], v[148:151], v[60:63]
    ds_read_b64_tr_b16 v[212:213], v6 offset:160
    v_exp_f32 v238, v130
    v_add_f32 v234, v234, v237
    v_cvt_pk_bf16_f32 v152, v236, v237
    v_mfma_f32_16x16x32_bf16 v[56:59], v[196:199], v[144:147], v[56:59]
    ds_read_b64_tr_b16 v[214:215], v6 offset:672
    v_exp_f32 v239, v131
    v_add_f32 v234, v234, v238
    s_waitcnt lgkmcnt(6)
    v_mfma_f32_16x16x32_bf16 v[64:67], v[200:203], v[144:147], v[64:67]
    ds_read_b64_tr_b16 v[216:217], v6 offset:192
    v_exp_f32 v236, v132
    v_add_f32 v234, v234, v239
    v_cvt_pk_bf16_f32 v153, v238, v239
    v_mfma_f32_16x16x32_bf16 v[68:71], v[200:203], v[148:151], v[68:71]
    ds_read_b64_tr_b16 v[218:219], v6 offset:704
    v_exp_f32 v237, v133
    v_add_f32 v234, v234, v236
    s_waitcnt lgkmcnt(6)
    v_mfma_f32_16x16x32_bf16 v[76:79], v[204:207], v[148:151], v[76:79]
    ds_read_b64_tr_b16 v[220:221], v6 offset:224
    v_exp_f32 v238, v134
    v_add_f32 v234, v234, v237
    v_cvt_pk_bf16_f32 v154, v236, v237
    v_mfma_f32_16x16x32_bf16 v[72:75], v[204:207], v[144:147], v[72:75]
    ds_read_b64_tr_b16 v[222:223], v6 offset:736
    v_exp_f32 v239, v135
    v_add_f32 v234, v234, v238
    s_waitcnt lgkmcnt(6)
    v_mfma_f32_16x16x32_bf16 v[80:83], v[208:211], v[144:147], v[80:83]
    buffer_load_dwordx4 v1, s[24:27], s34 offen lds
    v_exp_f32 v236, v136
    v_add_f32 v234, v234, v239
    v_cvt_pk_bf16_f32 v155, v238, v239
    v_mfma_f32_16x16x32_bf16 v[84:87], v[208:211], v[148:151], v[84:87]
    s_xor_b32 s37, s37, 0x4200
    v_exp_f32 v237, v137
    v_add_f32 v235, v233, v236
    s_waitcnt lgkmcnt(4)
    v_mfma_f32_16x16x32_bf16 v[92:95], v[212:215], v[148:151], v[92:95]
    s_sub_u32 s43, s35, 8448
    v_exp_f32 v238, v138
    v_add_f32 v235, v235, v237
    v_cvt_pk_bf16_f32 v156, v236, v237
    v_mfma_f32_16x16x32_bf16 v[88:91], v[212:215], v[144:147], v[88:91]
    s_cmp_lt_u32 s43, 0xffff5b00
    v_exp_f32 v239, v139
    v_add_f32 v235, v235, v238
    s_waitcnt lgkmcnt(2)
    v_mfma_f32_16x16x32_bf16 v[96:99], v[216:219], v[144:147], v[96:99]
    s_cselect_b32 s43, 0xffffdf00, s43
    v_exp_f32 v236, v140
    v_add_f32 v235, v235, v239
    v_cvt_pk_bf16_f32 v157, v238, v239
    v_mfma_f32_16x16x32_bf16 v[100:103], v[216:219], v[148:151], v[100:103]
    buffer_load_dwordx4 v2, s[24:27], s34 offen offset:1056 lds
    v_exp_f32 v237, v141
    v_add_f32 v235, v235, v236
    s_waitcnt lgkmcnt(0)
    v_mfma_f32_16x16x32_bf16 v[108:111], v[220:223], v[148:151], v[108:111]
    s_mov_b32 s44, s38
    v_exp_f32 v238, v142
    v_add_f32 v235, v235, v237
    v_cvt_pk_bf16_f32 v158, v236, v237
    v_mfma_f32_16x16x32_bf16 v[104:107], v[220:223], v[144:147], v[104:107]
    s_add_u32 s34, s34, 131072
    v_exp_f32 v239, v143
    v_add_f32 v235, v235, v238
    v_add_u32 v6, s37, v4
    v_add_f32 v235, v235, v239
    v_cvt_pk_bf16_f32 v159, v238, v239
    v_max_f32 v11, v234, v235
    v_cmp_lt_f32 vcc, s52, v11
    s_cmp_eq_u32 s19, 0
    s_cbranch_vccnz L_fbT1
L_fbretT1:
L_trans1:
    s_lshr_b32 s51, s19, 22
    s_add_u32 s51, s51, s32
    s_and_b32 s51, s51, 3
    s_add_u32 s45, s51, 1
    s_mul_i32 s45, s45, 8448
    s_add_u32 s45, s45, s43
    s_cselect_b32 s46, 0xffff5b00, 0
    s_add_u32 s45, s45, s46
    v_add_u32 v5, s45, v3
    s_cmp_ge_u32 s32, 2
    s_cselect_b32 s45, s37, s44
    s_waitcnt vmcnt(6)
    s_barrier
    ds_read_b64_tr_b16 v[192:193], v6 offset:0
    ds_read_b64_tr_b16 v[194:195], v6 offset:512
    ds_read_b64_tr_b16 v[196:197], v6 offset:32
    ds_read_b64_tr_b16 v[198:199], v6 offset:544
    ds_read_b64_tr_b16 v[200:201], v6 offset:64
    ds_read_b64_tr_b16 v[202:203], v6 offset:576
    v_permlane32_swap_b32 v234, v235
    ds_read_b128 v[160:163], v5 offset:0
    ds_read_b128 v[176:179], v5 offset:512
    v_add_f32 v234, v234, v235
    v_mov_b32 v235, v234
    ds_read_b64_tr_b16 v[204:205], v6 offset:96
    ds_read_b64_tr_b16 v[206:207], v6 offset:608
    v_permlane16_swap_b32 v234, v235
    ds_read_b64_tr_b16 v[208:209], v6 offset:128
    ds_read_b64_tr_b16 v[210:211], v6 offset:640
    v_add_f32 v234, v234, v235
    v_mov_b32 v235, v234
    ds_read_b64_tr_b16 v[212:213], v6 offset:160
    ds_read_b64_tr_b16 v[214:215], v6 offset:672
    v_permlane32_swap_b32 v234, v235
    ds_read_b64_tr_b16 v[216:217], v6 offset:192
    ds_read_b64_tr_b16 v[218:219], v6 offset:704
    s_waitcnt lgkmcnt(14)
    v_mfma_f32_16x16x32_bf16 v[48:51], v[192:195], v[152:155], v[48:51]
    ds_read_b64_tr_b16 v[220:221], v6 offset:224
    ds_read_b64_tr_b16 v[222:223], v6 offset:736
    v_rcp_f32 v245, v234
    v_rcp_f32 v246, v235
    v_mov_b32 v224, 0
    v_mov_b32 v225, 0
    v_mfma_f32_16x16x32_bf16 v[52:55], v[192:195], v[156:159], v[52:55]
    ds_read_b128 v[164:167], v5 offset:64
    ds_read_b128 v[180:183], v5 offset:576
    v_add_u32 v240, s45, v7
    v_add_u32 v244, s45, v8
    v_xor_b32 v241, 32, v240
    v_mov_b32 v226, 0
    v_mov_b32 v227, 0
    s_waitcnt lgkmcnt(15)
    v_mfma_f32_16x16x32_bf16 v[60:63], v[196:199], v[156:159], v[60:63]
    ds_read_b128 v[168:171], v5 offset:128
    ds_read_b128 v[184:187], v5 offset:640
    v_xor_b32 v242, 64, v240
    v_xor_b32 v243, 96, v240
    v_mov_b32 v228, 0
    v_mov_b32 v229, 0
    v_mov_b32 v230, 0
    v_mov_b32 v231, 0
    v_mfma_f32_16x16x32_bf16 v[56:59], v[196:199], v[152:155], v[56:59]
    ds_read_b128 v[172:175], v5 offset:192
    ds_read_b128 v[188:191], v5 offset:704
    s_waitcnt lgkmcnt(15)
    s_add_u32 s46, s3, s13
    s_mov_b32 s30, s14
    v_lshlrev_b32 v128, 16, v160
    v_and_b32 v129, 0xffff0000, v160
    v_lshlrev_b32 v130, 16, v161
    v_and_b32 v131, 0xffff0000, v161
    v_mul_f32 v128, s50, v128
    v_mul_f32 v129, s50, v129
    v_mfma_f32_16x16x32_bf16 v[64:67], v[200:203], v[152:155], v[64:67]
    v_add_u32 v5, s43, v3
    s_add_u32 s47, s46, 32768
    s_add_u32 s48, s46, 65536
    v_mul_f32 v130, s50, v130
    v_mul_f32 v131, s50, v131
    v_cvt_pk_bf16_f32 v16, v128, v129
    v_cvt_pk_bf16_f32 v17, v130, v131
    v_lshlrev_b32 v132, 16, v162
    v_and_b32 v133, 0xffff0000, v162
    v_mfma_f32_16x16x32_bf16 v[68:71], v[200:203], v[156:159], v[68:71]
    s_add_u32 s53, s46, 98304
    s_lshl_b32 s3, s51, 17
    v_lshlrev_b32 v134, 16, v163
    v_and_b32 v135, 0xffff0000, v163
    v_mul_f32 v132, s50, v132
    v_mul_f32 v133, s50, v133
    v_mul_f32 v134, s50, v134
    v_mul_f32 v135, s50, v135
    s_waitcnt lgkmcnt(14)
    v_mfma_f32_16x16x32_bf16 v[76:79], v[204:207], v[156:159], v[76:79]
    s_add_u32 s35, s43, 8448
    s_cselect_b32 s35, 0xffff5b00, s35
    v_cvt_pk_bf16_f32 v18, v132, v133
    v_cvt_pk_bf16_f32 v19, v134, v135
    v_lshlrev_b32 v136, 16, v176
    v_and_b32 v137, 0xffff0000, v176
    v_lshlrev_b32 v138, 16, v177
    v_and_b32 v139, 0xffff0000, v177
    v_mfma_f32_16x16x32_bf16 v[72:75], v[204:207], v[152:155], v[72:75]
    v_mul_f32 v136, s50, v136
    v_mul_f32 v137, s50, v137
    v_mul_f32 v138, s50, v138
    v_mul_f32 v139, s50, v139
    v_cvt_pk_bf16_f32 v32, v136, v137
    v_cvt_pk_bf16_f32 v33, v138, v139
    s_add_u32 m0, s40, s35
    v_lshlrev_b32 v140, 16, v178
    v_and_b32 v141, 0xffff0000, v178
    v_lshlrev_b32 v142, 16, v179
    v_and_b32 v143, 0xffff0000, v179
    v_mul_f32 v140, s50, v140
    v_mul_f32 v141, s50, v141
    v_mul_f32 v142, s50, v142
    v_mul_f32 v143, s50, v143
    v_cvt_pk_bf16_f32 v34, v140, v141
    v_cvt_pk_bf16_f32 v35, v142, v143
    s_waitcnt vmcnt(2) lgkmcnt(0)
    s_barrier
    v_mfma_f32_16x16x32_bf16 v[80:83], v[208:211], v[152:155], v[80:83]
    buffer_load_dwordx4 v1, s[20:23], s33 offen lds
    v_mul_f32 v48, v48, v245
    v_mul_f32 v49, v49, v245
    v_mul_f32 v50, v50, v245
    v_mul_f32 v51, v51, v245
    v_mul_f32 v52, v52, v246
    v_mul_f32 v53, v53, v246
    v_cvt_pk_bf16_f32 v48, v48, v49
    v_mfma_f32_16x16x32_bf16 v[84:87], v[208:211], v[156:159], v[84:87]
    v_cvt_pk_bf16_f32 v49, v50, v51
    v_mul_f32 v54, v54, v246
    v_mul_f32 v55, v55, v246
    ds_write_b64 v240, v[48:49] offset:0
    v_cvt_pk_bf16_f32 v52, v52, v53
    v_cvt_pk_bf16_f32 v53, v54, v55
    ds_write_b64 v240, v[52:53] offset:2048
    v_mfma_f32_16x16x32_bf16 v[92:95], v[212:215], v[156:159], v[92:95]
    buffer_load_dwordx4 v2, s[20:23], s33 offen offset:1056 lds
    v_mul_f32 v56, v56, v245
    v_mul_f32 v57, v57, v245
    v_mul_f32 v58, v58, v245
    v_mul_f32 v59, v59, v245
    v_mul_f32 v60, v60, v246
    v_mul_f32 v61, v61, v246
    v_cvt_pk_bf16_f32 v56, v56, v57
    v_mfma_f32_16x16x32_bf16 v[88:91], v[212:215], v[152:155], v[88:91]
    s_add_u32 s33, s33, 131072
    s_add_u32 s35, s35, 8448
    s_cselect_b32 s35, 0xffff5b00, s35
    s_add_u32 m0, s40, s35
    v_cvt_pk_bf16_f32 v57, v58, v59
    v_mul_f32 v62, v62, v246
    v_mul_f32 v63, v63, v246
    ds_write_b64 v241, v[56:57] offset:0
    v_cvt_pk_bf16_f32 v60, v60, v61
    v_cvt_pk_bf16_f32 v61, v62, v63
    ds_write_b64 v241, v[60:61] offset:2048
    v_mfma_f32_16x16x32_bf16 v[96:99], v[216:219], v[152:155], v[96:99]
    buffer_load_dwordx4 v1, s[20:23], s33 offen lds
    v_mul_f32 v64, v64, v245
    v_mul_f32 v65, v65, v245
    v_mul_f32 v66, v66, v245
    v_mul_f32 v67, v67, v245
    v_mul_f32 v68, v68, v246
    v_mul_f32 v69, v69, v246
    v_cvt_pk_bf16_f32 v64, v64, v65
    v_mfma_f32_16x16x32_bf16 v[100:103], v[216:219], v[156:159], v[100:103]
    v_cvt_pk_bf16_f32 v65, v66, v67
    v_mul_f32 v70, v70, v246
    v_mul_f32 v71, v71, v246
    ds_write_b64 v242, v[64:65] offset:0
    v_cvt_pk_bf16_f32 v68, v68, v69
    v_cvt_pk_bf16_f32 v69, v70, v71
    ds_write_b64 v242, v[68:69] offset:2048
    v_mfma_f32_16x16x32_bf16 v[108:111], v[220:223], v[156:159], v[108:111]
    buffer_load_dwordx4 v2, s[20:23], s33 offen offset:1056 lds
    v_mul_f32 v72, v72, v245
    v_mul_f32 v73, v73, v245
    v_mul_f32 v74, v74, v245
    v_mul_f32 v75, v75, v245
    v_mul_f32 v76, v76, v246
    v_mul_f32 v77, v77, v246
    v_cvt_pk_bf16_f32 v72, v72, v73
    v_mfma_f32_16x16x32_bf16 v[104:107], v[220:223], v[152:155], v[104:107]
    s_add_u32 s33, s33, 131072
    s_add_u32 s35, s35, 8448
    s_cselect_b32 s35, 0xffff5b00, s35
    s_add_u32 m0, s40, s35
    v_cvt_pk_bf16_f32 v73, v74, v75
    v_mul_f32 v78, v78, v246
    v_mul_f32 v79, v79, v246
    ds_write_b64 v243, v[72:73] offset:0
    v_cvt_pk_bf16_f32 v76, v76, v77
    v_cvt_pk_bf16_f32 v77, v78, v79
    ds_write_b64 v243, v[76:77] offset:2048
    ds_read_b128 v[48:51], v244 offset:0
    ds_read_b64 v[52:53], v244 offset:1032
    ds_read_b64 v[54:55], v244 offset:1024
    ds_read_b128 v[56:59], v244 offset:2048
    ds_read_b64 v[60:61], v244 offset:3080
    ds_read_b64 v[62:63], v244 offset:3072
    ds_read_b128 v[192:195], v5 offset:0
    ds_read_b128 v[208:211], v5 offset:512
    ds_read_b128 v[196:199], v5 offset:64
    ds_read_b128 v[212:215], v5 offset:576
    ds_read_b128 v[200:203], v5 offset:128
    ds_read_b128 v[216:219], v5 offset:640
    ds_read_b128 v[204:207], v5 offset:192
    ds_read_b128 v[220:223], v5 offset:704
    v_mul_f32 v80, v80, v245
    v_mul_f32 v81, v81, v245
    v_mul_f32 v82, v82, v245
    v_mul_f32 v83, v83, v245
    v_mul_f32 v84, v84, v246
    v_mul_f32 v85, v85, v246
    v_cvt_pk_bf16_f32 v80, v80, v81
    v_cvt_pk_bf16_f32 v81, v82, v83
    v_mul_f32 v86, v86, v246
    v_mul_f32 v87, v87, v246
    s_waitcnt lgkmcnt(13)
    buffer_store_dwordx4 v[48:51], v9, s[28:31], s46 offen offset:0 nt
    ds_write_b64 v240, v[80:81] offset:0
    v_cvt_pk_bf16_f32 v84, v84, v85
    v_cvt_pk_bf16_f32 v85, v86, v87
    ds_write_b64 v240, v[84:85] offset:2048
    v_mul_f32 v88, v88, v245
    v_mul_f32 v89, v89, v245
    v_mul_f32 v90, v90, v245
    v_mul_f32 v91, v91, v245
    v_mul_f32 v92, v92, v246
    v_mul_f32 v93, v93, v246
    v_cvt_pk_bf16_f32 v88, v88, v89
    v_cvt_pk_bf16_f32 v89, v90, v91
    s_waitcnt lgkmcnt(13)
    buffer_store_dwordx4 v[52:55], v9, s[28:31], s47 offen offset:0 nt
    v_mul_f32 v94, v94, v246
    v_mul_f32 v95, v95, v246
    ds_write_b64 v241, v[88:89] offset:0
    v_cvt_pk_bf16_f32 v92, v92, v93
    v_cvt_pk_bf16_f32 v93, v94, v95
    ds_write_b64 v241, v[92:93] offset:2048
    v_mul_f32 v96, v96, v245
    v_mul_f32 v97, v97, v245
    v_mul_f32 v98, v98, v245
    v_mul_f32 v99, v99, v245
    v_mul_f32 v100, v100, v246
    v_mul_f32 v101, v101, v246
    s_waitcnt lgkmcnt(14)
    buffer_store_dwordx4 v[56:59], v9, s[28:31], s48 offen offset:0 nt
    v_cvt_pk_bf16_f32 v96, v96, v97
    v_cvt_pk_bf16_f32 v97, v98, v99
    v_mul_f32 v102, v102, v246
    v_mul_f32 v103, v103, v246
    ds_write_b64 v242, v[96:97] offset:0
    v_cvt_pk_bf16_f32 v100, v100, v101
    v_cvt_pk_bf16_f32 v101, v102, v103
    ds_write_b64 v242, v[100:101] offset:2048
    v_mul_f32 v104, v104, v245
    v_mul_f32 v105, v105, v245
    v_mul_f32 v106, v106, v245
    v_mul_f32 v107, v107, v245
    s_waitcnt lgkmcnt(14)
    buffer_store_dwordx4 v[60:63], v9, s[28:31], s53 offen offset:0 nt
    v_mul_f32 v108, v108, v246
    v_mul_f32 v109, v109, v246
    v_cvt_pk_bf16_f32 v104, v104, v105
    v_cvt_pk_bf16_f32 v105, v106, v107
    v_mul_f32 v110, v110, v246
    v_mul_f32 v111, v111, v246
    ds_write_b64 v243, v[104:105] offset:0
    v_cvt_pk_bf16_f32 v108, v108, v109
    v_cvt_pk_bf16_f32 v109, v110, v111
    ds_write_b64 v243, v[108:109] offset:2048
    ds_read_b128 v[80:83], v244 offset:0
    ds_read_b64 v[84:85], v244 offset:1032
    ds_read_b64 v[86:87], v244 offset:1024
    ds_read_b128 v[88:91], v244 offset:2048
    ds_read_b64 v[92:93], v244 offset:3080
    ds_read_b64 v[94:95], v244 offset:3072
    s_nop 1
    s_waitcnt lgkmcnt(15)
    v_mfma_f32_16x16x32_bf16 v[112:115], v[192:195], v[16:19], v[224:227]
    buffer_load_dwordx4 v1, s[20:23], s33 offen lds
    v_lshlrev_b32 v128, 16, v164
    v_and_b32 v129, 0xffff0000, v164
    v_lshlrev_b32 v130, 16, v165
    v_and_b32 v131, 0xffff0000, v165
    v_mul_f32 v128, s50, v128
    v_mul_f32 v129, s50, v129
    v_mul_f32 v130, s50, v130
    v_mul_f32 v131, s50, v131
    v_cvt_pk_bf16_f32 v20, v128, v129
    v_cvt_pk_bf16_f32 v21, v130, v131
    v_mfma_f32_16x16x32_bf16 v[120:123], v[192:195], v[32:35], v[228:231]
    v_lshlrev_b32 v132, 16, v166
    v_and_b32 v133, 0xffff0000, v166
    v_lshlrev_b32 v134, 16, v167
    v_and_b32 v135, 0xffff0000, v167
    v_mul_f32 v132, s50, v132
    v_mul_f32 v133, s50, v133
    v_mul_f32 v134, s50, v134
    v_mul_f32 v135, s50, v135
    v_cvt_pk_bf16_f32 v22, v132, v133
    v_cvt_pk_bf16_f32 v23, v134, v135
    v_mfma_f32_16x16x32_bf16 v[124:127], v[208:211], v[32:35], v[228:231]
    buffer_load_dwordx4 v2, s[20:23], s33 offen offset:1056 lds
    v_lshlrev_b32 v136, 16, v180
    v_and_b32 v137, 0xffff0000, v180
    v_lshlrev_b32 v138, 16, v181
    v_and_b32 v139, 0xffff0000, v181
    v_mul_f32 v136, s50, v136
    v_mul_f32 v137, s50, v137
    v_mul_f32 v138, s50, v138
    v_mul_f32 v139, s50, v139
    v_cvt_pk_bf16_f32 v36, v136, v137
    v_cvt_pk_bf16_f32 v37, v138, v139
    v_mfma_f32_16x16x32_bf16 v[116:119], v[208:211], v[16:19], v[224:227]
    s_add_u32 s33, s33, 131072
    s_add_u32 s35, s35, 8448
    s_cselect_b32 s35, 0xffff5b00, s35
    s_add_u32 m0, s40, s35
    v_lshlrev_b32 v140, 16, v182
    v_and_b32 v141, 0xffff0000, v182
    v_lshlrev_b32 v142, 16, v183
    v_and_b32 v143, 0xffff0000, v183
    v_mul_f32 v140, s50, v140
    v_mul_f32 v141, s50, v141
    v_mul_f32 v142, s50, v142
    v_mul_f32 v143, s50, v143
    v_cvt_pk_bf16_f32 v38, v140, v141
    v_cvt_pk_bf16_f32 v39, v142, v143
    s_nop 1
    v_mfma_f32_16x16x32_bf16 v[112:115], v[196:199], v[20:23], v[112:115]
    s_waitcnt lgkmcnt(5)
    buffer_store_dwordx4 v[80:83], v9, s[28:31], s46 offen offset:128 nt
    v_lshlrev_b32 v128, 16, v168
    v_and_b32 v129, 0xffff0000, v168
    v_lshlrev_b32 v130, 16, v169
    v_and_b32 v131, 0xffff0000, v169
    v_mul_f32 v128, s50, v128
    v_mul_f32 v129, s50, v129
    v_mul_f32 v130, s50, v130
    v_mul_f32 v131, s50, v131
    v_cvt_pk_bf16_f32 v24, v128, v129
    v_cvt_pk_bf16_f32 v25, v130, v131
    v_mfma_f32_16x16x32_bf16 v[120:123], v[196:199], v[36:39], v[120:123]
    v_lshlrev_b32 v132, 16, v170
    v_and_b32 v133, 0xffff0000, v170
    v_lshlrev_b32 v134, 16, v171
    v_and_b32 v135, 0xffff0000, v171
    v_mul_f32 v132, s50, v132
    v_mul_f32 v133, s50, v133
    v_mul_f32 v134, s50, v134
    v_mul_f32 v135, s50, v135
    v_cvt_pk_bf16_f32 v26, v132, v133
    v_cvt_pk_bf16_f32 v27, v134, v135
    v_mfma_f32_16x16x32_bf16 v[124:127], v[212:215], v[36:39], v[124:127]
    s_waitcnt lgkmcnt(3)
    buffer_store_dwordx4 v[84:87], v9, s[28:31], s47 offen offset:128 nt
    v_lshlrev_b32 v136, 16, v184
    v_and_b32 v137, 0xffff0000, v184
    v_lshlrev_b32 v138, 16, v185
    v_and_b32 v139, 0xffff0000, v185
    v_mul_f32 v136, s50, v136
    v_mul_f32 v137, s50, v137
    v_mul_f32 v138, s50, v138
    v_mul_f32 v139, s50, v139
    v_cvt_pk_bf16_f32 v40, v136, v137
    v_cvt_pk_bf16_f32 v41, v138, v139
    v_mfma_f32_16x16x32_bf16 v[116:119], v[212:215], v[20:23], v[116:119]
    v_lshlrev_b32 v140, 16, v186
    v_and_b32 v141, 0xffff0000, v186
    v_lshlrev_b32 v142, 16, v187
    v_and_b32 v143, 0xffff0000, v187
    v_mul_f32 v140, s50, v140
    v_mul_f32 v141, s50, v141
    v_mul_f32 v142, s50, v142
    v_mul_f32 v143, s50, v143
    v_cvt_pk_bf16_f32 v42, v140, v141
    v_cvt_pk_bf16_f32 v43, v142, v143
    s_nop 1
    v_mfma_f32_16x16x32_bf16 v[112:115], v[200:203], v[24:27], v[112:115]
    s_waitcnt lgkmcnt(2)
    buffer_store_dwordx4 v[88:91], v9, s[28:31], s48 offen offset:128 nt
    v_lshlrev_b32 v128, 16, v172
    v_and_b32 v129, 0xffff0000, v172
    v_lshlrev_b32 v130, 16, v173
    v_and_b32 v131, 0xffff0000, v173
    v_mul_f32 v128, s50, v128
    v_mul_f32 v129, s50, v129
    v_mul_f32 v130, s50, v130
    v_mul_f32 v131, s50, v131
    v_cvt_pk_bf16_f32 v28, v128, v129
    v_cvt_pk_bf16_f32 v29, v130, v131
    v_mfma_f32_16x16x32_bf16 v[120:123], v[200:203], v[40:43], v[120:123]
    v_lshlrev_b32 v132, 16, v174
    v_and_b32 v133, 0xffff0000, v174
    v_lshlrev_b32 v134, 16, v175
    v_and_b32 v135, 0xffff0000, v175
    v_mul_f32 v132, s50, v132
    v_mul_f32 v133, s50, v133
    v_mul_f32 v134, s50, v134
    v_mul_f32 v135, s50, v135
    v_cvt_pk_bf16_f32 v30, v132, v133
    v_cvt_pk_bf16_f32 v31, v134, v135
    v_mfma_f32_16x16x32_bf16 v[124:127], v[216:219], v[40:43], v[124:127]
    s_waitcnt lgkmcnt(0)
    buffer_store_dwordx4 v[92:95], v9, s[28:31], s53 offen offset:128 nt
    v_lshlrev_b32 v136, 16, v188
    v_and_b32 v137, 0xffff0000, v188
    v_lshlrev_b32 v138, 16, v189
    v_and_b32 v139, 0xffff0000, v189
    v_mul_f32 v136, s50, v136
    v_mul_f32 v137, s50, v137
    v_mul_f32 v138, s50, v138
    v_mul_f32 v139, s50, v139
    v_cvt_pk_bf16_f32 v44, v136, v137
    v_cvt_pk_bf16_f32 v45, v138, v139
    v_mfma_f32_16x16x32_bf16 v[116:119], v[216:219], v[24:27], v[116:119]
    v_lshlrev_b32 v140, 16, v190
    v_and_b32 v141, 0xffff0000, v190
    v_lshlrev_b32 v142, 16, v191
    v_and_b32 v143, 0xffff0000, v191
    v_mul_f32 v140, s50, v140
    v_mul_f32 v141, s50, v141
    v_mul_f32 v142, s50, v142
    v_mul_f32 v143, s50, v143
    v_cvt_pk_bf16_f32 v46, v140, v141
    v_cvt_pk_bf16_f32 v47, v142, v143
    s_nop 1
    v_mfma_f32_16x16x32_bf16 v[112:115], v[204:207], v[28:31], v[112:115]
    buffer_load_dwordx4 v1, s[20:23], s33 offen lds
    s_mov_b64 s[12:13], s[16:17]
    s_mov_b64 s[14:15], s[18:19]
    v_mfma_f32_16x16x32_bf16 v[120:123], v[204:207], v[44:47], v[120:123]
    s_mov_b64 s[16:17], 0
    s_mov_b64 s[18:19], 0
    s_mov_b32 s62, 0
    v_mfma_f32_16x16x32_bf16 v[124:127], v[220:223], v[44:47], v[124:127]
    v_mfma_f32_16x16x32_bf16 v[116:119], v[220:223], v[28:31], v[116:119]
    buffer_load_dwordx4 v2, s[20:23], s33 offen offset:1056 lds
    s_add_u32 s33, s33, 131072
    s_waitcnt vmcnt(12)
    s_branch L_pre0
L_tailE1:
    s_xor_b32 s46, s37, 0x4200
    s_bfe_u32 s45, s15, 0x80008
    v_lshrrev_b32 v11, 4, v10
    v_lshlrev_b32 v11, 2, v11
    v_sub_u32 v11, s45, v11
    v_mov_b32 v12, 0xff800000
    v_add_u32 v247, s46, v4
    s_waitcnt vmcnt(6) lgkmcnt(0)
    s_barrier
    ds_read_b64_tr_b16 v[192:193], v6 offset:0
    ds_read_b64_tr_b16 v[194:195], v6 offset:512
    v_cmp_lt_i32 s[54:55], 0, v11
    v_cmp_lt_i32 s[56:57], 1, v11
    v_cmp_lt_i32 s[58:59], 2, v11
    v_cmp_lt_i32 s[60:61], 3, v11
    v_cndmask_b32 v128, v12, v128, s[54:55]
    v_cndmask_b32 v129, v12, v129, s[56:57]
    ds_read_b64_tr_b16 v[196:197], v6 offset:32
    ds_read_b64_tr_b16 v[198:199], v6 offset:544
    v_cndmask_b32 v130, v12, v130, s[58:59]
    v_cndmask_b32 v131, v12, v131, s[60:61]
    v_cndmask_b32 v136, v12, v136, s[54:55]
    v_cndmask_b32 v137, v12, v137, s[56:57]
    v_cndmask_b32 v138, v12, v138, s[58:59]
    v_cndmask_b32 v139, v12, v139, s[60:61]
    ds_read_b64_tr_b16 v[200:201], v6 offset:64
    ds_read_b64_tr_b16 v[202:203], v6 offset:576
    v_cmp_lt_i32 s[54:55], 16, v11
    v_cmp_lt_i32 s[56:57], 17, v11
    v_cmp_lt_i32 s[58:59], 18, v11
    v_cmp_lt_i32 s[60:61], 19, v11
    v_cndmask_b32 v132, v12, v132, s[54:55]
    v_cndmask_b32 v133, v12, v133, s[56:57]
    ds_read_b64_tr_b16 v[204:205], v6 offset:96
    ds_read_b64_tr_b16 v[206:207], v6 offset:608
    v_cndmask_b32 v134, v12, v134, s[58:59]
    v_cndmask_b32 v135, v12, v135, s[60:61]
    v_cndmask_b32 v140, v12, v140, s[54:55]
    v_cndmask_b32 v141, v12, v141, s[56:57]
    v_cndmask_b32 v142, v12, v142, s[58:59]
    v_cndmask_b32 v143, v12, v143, s[60:61]
    s_waitcnt lgkmcnt(6)
    v_mfma_f32_16x16x32_bf16 v[48:51], v[192:195], v[144:147], v[48:51]
    v_exp_f32 v236, v128
    ds_read_b64_tr_b16 v[208:209], v6 offset:128
    s_add_u32 s43, s36, 8448
    s_cselect_b32 s43, 0xffff5b00, s43
    v_mfma_f32_16x16x32_bf16 v[52:55], v[192:195], v[148:151], v[52:55]
    v_exp_f32 v237, v129
    ds_read_b64_tr_b16 v[210:211], v6 offset:640
    s_cmp_eq_u32 s32, 1
    s_cselect_b32 s43, s36, s43
    v_add_f32 v234, v232, v236
    s_waitcnt lgkmcnt(6)
    v_mfma_f32_16x16x32_bf16 v[60:63], v[196:199], v[148:151], v[60:63]
    v_exp_f32 v238, v130
    ds_read_b64_tr_b16 v[212:213], v6 offset:160
    s_cmp_eq_u32 s32, 0
    s_cselect_b32 s43, s35, s43
    v_add_f32 v234, v234, v237
    v_cvt_pk_bf16_f32 v152, v236, v237
    v_mfma_f32_16x16x32_bf16 v[56:59], v[196:199], v[144:147], v[56:59]
    v_exp_f32 v239, v131
    ds_read_b64_tr_b16 v[214:215], v6 offset:672
    s_add_u32 s43, s43, 76032
    s_cmp_eq_u32 s32, 3
    v_add_f32 v234, v234, v238
    s_waitcnt lgkmcnt(6)
    v_mfma_f32_16x16x32_bf16 v[64:67], v[200:203], v[144:147], v[64:67]
    v_exp_f32 v236, v132
    ds_read_b64_tr_b16 v[216:217], v6 offset:192
    s_cselect_b32 s43, s37, s43
    s_and_b32 s45, s32, 1
    v_add_f32 v234, v234, v239
    v_cvt_pk_bf16_f32 v153, v238, v239
    v_mfma_f32_16x16x32_bf16 v[68:71], v[200:203], v[148:151], v[68:71]
    v_exp_f32 v237, v133
    ds_read_b64_tr_b16 v[218:219], v6 offset:704
    s_lshl_b32 s45, s45, 12
    s_sub_u32 s45, s43, s45
    v_add_f32 v234, v234, v236
    s_waitcnt lgkmcnt(6)
    v_mfma_f32_16x16x32_bf16 v[76:79], v[204:207], v[148:151], v[76:79]
    v_exp_f32 v238, v134
    ds_read_b64_tr_b16 v[220:221], v6 offset:224
    s_add_u32 s46, s3, s13
    s_mov_b32 s30, s14
    v_add_f32 v234, v234, v237
    v_cvt_pk_bf16_f32 v154, v236, v237
    v_mfma_f32_16x16x32_bf16 v[72:75], v[204:207], v[144:147], v[72:75]
    v_exp_f32 v239, v135
    ds_read_b64_tr_b16 v[222:223], v6 offset:736
    s_add_u32 s47, s46, 32768
    s_add_u32 s48, s46, 65536
    v_add_f32 v234, v234, v238
    s_waitcnt lgkmcnt(6)
    v_mfma_f32_16x16x32_bf16 v[80:83], v[208:211], v[144:147], v[80:83]
    v_exp_f32 v236, v136
    ds_read_b64_tr_b16 v[160:161], v247 offset:0
    ds_read_b64_tr_b16 v[162:163], v247 offset:512
    s_add_u32 s53, s46, 98304
    v_add_f32 v234, v234, v239
    v_cvt_pk_bf16_f32 v155, v238, v239
    v_mfma_f32_16x16x32_bf16 v[84:87], v[208:211], v[148:151], v[84:87]
    v_exp_f32 v237, v137
    ds_read_b64_tr_b16 v[164:165], v247 offset:32
    ds_read_b64_tr_b16 v[166:167], v247 offset:544
    v_add_f32 v235, v233, v236
    v_add_u32 v240, s45, v7
    s_waitcnt lgkmcnt(8)
    v_mfma_f32_16x16x32_bf16 v[92:95], v[212:215], v[148:151], v[92:95]
    v_exp_f32 v238, v138
    ds_read_b64_tr_b16 v[168:169], v247 offset:64
    ds_read_b64_tr_b16 v[170:171], v247 offset:576
    v_add_f32 v235, v235, v237
    v_cvt_pk_bf16_f32 v156, v236, v237
    v_mfma_f32_16x16x32_bf16 v[88:91], v[212:215], v[144:147], v[88:91]
    v_exp_f32 v239, v139
    ds_read_b64_tr_b16 v[172:173], v247 offset:96
    ds_read_b64_tr_b16 v[174:175], v247 offset:608
    v_add_f32 v235, v235, v238
    v_add_u32 v244, s45, v8
    s_waitcnt lgkmcnt(10)
    v_mfma_f32_16x16x32_bf16 v[96:99], v[216:219], v[144:147], v[96:99]
    v_exp_f32 v236, v140
    ds_read_b64_tr_b16 v[176:177], v247 offset:128
    ds_read_b64_tr_b16 v[178:179], v247 offset:640
    v_add_f32 v235, v235, v239
    v_cvt_pk_bf16_f32 v157, v238, v239
    v_mfma_f32_16x16x32_bf16 v[100:103], v[216:219], v[148:151], v[100:103]
    v_exp_f32 v237, v141
    ds_read_b64_tr_b16 v[180:181], v247 offset:160
    ds_read_b64_tr_b16 v[182:183], v247 offset:672
    v_add_f32 v235, v235, v236
    v_xor_b32 v241, 32, v240
    s_waitcnt lgkmcnt(12)
    v_mfma_f32_16x16x32_bf16 v[108:111], v[220:223], v[148:151], v[108:111]
    v_exp_f32 v238, v142
    ds_read_b64_tr_b16 v[184:185], v247 offset:192
    ds_read_b64_tr_b16 v[186:187], v247 offset:704
    v_add_f32 v235, v235, v237
    v_cvt_pk_bf16_f32 v158, v236, v237
    v_mfma_f32_16x16x32_bf16 v[104:107], v[220:223], v[144:147], v[104:107]
    v_exp_f32 v239, v143
    ds_read_b64_tr_b16 v[188:189], v247 offset:224
    ds_read_b64_tr_b16 v[190:191], v247 offset:736
    v_add_f32 v235, v235, v238
    v_xor_b32 v242, 64, v240
    v_xor_b32 v243, 96, v240
    v_add_f32 v235, v235, v239
    v_cvt_pk_bf16_f32 v159, v238, v239
    v_max_f32 v11, v234, v235
    v_cmp_lt_f32 vcc, s52, v11
    s_cmp_eq_u32 s19, 0
    s_cbranch_vccnz L_fbT1
L_fbretE1:
    s_setprio 0
    s_waitcnt lgkmcnt(14)
    v_mfma_f32_16x16x32_bf16 v[48:51], v[160:163], v[152:155], v[48:51]
    v_permlane32_swap_b32 v234, v235
    v_add_f32 v234, v234, v235
    v_mov_b32 v235, v234
    s_waitcnt lgkmcnt(12)
    v_mfma_f32_16x16x32_bf16 v[56:59], v[164:167], v[152:155], v[56:59]
    s_nop 0
    v_permlane16_swap_b32 v234, v235
    v_add_f32 v234, v234, v235
    v_mov_b32 v235, v234
    s_waitcnt lgkmcnt(10)
    v_mfma_f32_16x16x32_bf16 v[64:67], v[168:171], v[152:155], v[64:67]
    s_nop 0
    v_permlane32_swap_b32 v234, v235
    v_rcp_f32 v245, v234
    s_waitcnt lgkmcnt(8)
    v_mfma_f32_16x16x32_bf16 v[72:75], v[172:175], v[152:155], v[72:75]
    v_rcp_f32 v246, v235
    v_mfma_f32_16x16x32_bf16 v[52:55], v[160:163], v[156:159], v[52:55]
    v_mul_f32 v48, v48, v245
    v_mul_f32 v49, v49, v245
    v_mul_f32 v50, v50, v245
    v_mfma_f32_16x16x32_bf16 v[60:63], v[164:167], v[156:159], v[60:63]
    v_mul_f32 v51, v51, v245
    v_cvt_pk_bf16_f32 v48, v48, v49
    v_cvt_pk_bf16_f32 v49, v50, v51
    ds_write_b64 v240, v[48:49] offset:0
    v_mfma_f32_16x16x32_bf16 v[68:71], v[168:171], v[156:159], v[68:71]
    v_mul_f32 v56, v56, v245
    v_mul_f32 v57, v57, v245
    v_mul_f32 v58, v58, v245
    v_mul_f32 v59, v59, v245
    v_mfma_f32_16x16x32_bf16 v[76:79], v[172:175], v[156:159], v[76:79]
    v_cvt_pk_bf16_f32 v56, v56, v57
    v_cvt_pk_bf16_f32 v57, v58, v59
    ds_write_b64 v241, v[56:57] offset:0
    v_mul_f32 v64, v64, v245
    s_waitcnt lgkmcnt(8)
    v_mfma_f32_16x16x32_bf16 v[80:83], v[176:179], v[152:155], v[80:83]
    v_mul_f32 v65, v65, v245
    v_mul_f32 v66, v66, v245
    v_mul_f32 v67, v67, v245
    v_cvt_pk_bf16_f32 v64, v64, v65
    s_waitcnt lgkmcnt(6)
    v_mfma_f32_16x16x32_bf16 v[88:91], v[180:183], v[152:155], v[88:91]
    v_cvt_pk_bf16_f32 v65, v66, v67
    ds_write_b64 v242, v[64:65] offset:0
    v_mul_f32 v72, v72, v245
    v_mul_f32 v73, v73, v245
    s_waitcnt lgkmcnt(5)
    v_mfma_f32_16x16x32_bf16 v[96:99], v[184:187], v[152:155], v[96:99]
    v_mul_f32 v74, v74, v245
    v_mul_f32 v75, v75, v245
    v_cvt_pk_bf16_f32 v72, v72, v73
    v_cvt_pk_bf16_f32 v73, v74, v75
    s_waitcnt lgkmcnt(3)
    v_mfma_f32_16x16x32_bf16 v[104:107], v[188:191], v[152:155], v[104:107]
    ds_write_b64 v243, v[72:73] offset:0
    ds_read_b128 v[112:115], v244 offset:0
    ds_read_b64 v[116:117], v244 offset:1032
    ds_read_b64 v[118:119], v244 offset:1024
    v_mul_f32 v52, v52, v246
    v_mul_f32 v53, v53, v246
    v_mul_f32 v54, v54, v246
    v_mfma_f32_16x16x32_bf16 v[84:87], v[176:179], v[156:159], v[84:87]
    v_mul_f32 v55, v55, v246
    v_cvt_pk_bf16_f32 v52, v52, v53
    v_cvt_pk_bf16_f32 v53, v54, v55
    ds_write_b64 v240, v[52:53] offset:2048
    v_mfma_f32_16x16x32_bf16 v[92:95], v[180:183], v[156:159], v[92:95]
    v_mul_f32 v60, v60, v246
    v_mul_f32 v61, v61, v246
    v_mul_f32 v62, v62, v246
    v_mul_f32 v63, v63, v246
    v_mfma_f32_16x16x32_bf16 v[100:103], v[184:187], v[156:159], v[100:103]
    v_cvt_pk_bf16_f32 v60, v60, v61
    v_cvt_pk_bf16_f32 v61, v62, v63
    ds_write_b64 v241, v[60:61] offset:2048
    v_mul_f32 v68, v68, v246
    v_mfma_f32_16x16x32_bf16 v[108:111], v[188:191], v[156:159], v[108:111]
    v_mul_f32 v69, v69, v246
    v_mul_f32 v70, v70, v246
    v_mul_f32 v71, v71, v246
    s_waitcnt lgkmcnt(4)
    buffer_store_dwordx4 v[112:115], v9, s[28:31], s46 offen offset:0 nt
    v_cvt_pk_bf16_f32 v68, v68, v69
    v_cvt_pk_bf16_f32 v69, v70, v71
    ds_write_b64 v242, v[68:69] offset:2048
    v_mul_f32 v76, v76, v246
    v_mul_f32 v77, v77, v246
    v_mul_f32 v78, v78, v246
    s_waitcnt lgkmcnt(3)
    buffer_store_dwordx4 v[116:119], v9, s[28:31], s47 offen offset:0 nt
    v_mul_f32 v79, v79, v246
    v_cvt_pk_bf16_f32 v76, v76, v77
    v_cvt_pk_bf16_f32 v77, v78, v79
    ds_write_b64 v243, v[76:77] offset:2048
    ds_read_b128 v[120:123], v244 offset:2048
    ds_read_b64 v[124:125], v244 offset:3080
    ds_read_b64 v[126:127], v244 offset:3072
    v_mul_f32 v80, v80, v245
    v_mul_f32 v81, v81, v245
    v_mul_f32 v82, v82, v245
    v_mul_f32 v83, v83, v245
    v_cvt_pk_bf16_f32 v80, v80, v81
    v_cvt_pk_bf16_f32 v81, v82, v83
    ds_write_b64 v240, v[80:81] offset:4096
    v_mul_f32 v88, v88, v245
    v_mul_f32 v89, v89, v245
    v_mul_f32 v90, v90, v245
    v_mul_f32 v91, v91, v245
    v_cvt_pk_bf16_f32 v88, v88, v89
    v_cvt_pk_bf16_f32 v89, v90, v91
    ds_write_b64 v241, v[88:89] offset:4096
    v_mul_f32 v96, v96, v245
    v_mul_f32 v97, v97, v245
    v_mul_f32 v98, v98, v245
    v_mul_f32 v99, v99, v245
    s_waitcnt lgkmcnt(4)
    buffer_store_dwordx4 v[120:123], v9, s[28:31], s48 offen offset:0 nt
    v_cvt_pk_bf16_f32 v96, v96, v97
    v_cvt_pk_bf16_f32 v97, v98, v99
    ds_write_b64 v242, v[96:97] offset:4096
    v_mul_f32 v104, v104, v245
    v_mul_f32 v105, v105, v245
    v_mul_f32 v106, v106, v245
    s_waitcnt lgkmcnt(3)
    buffer_store_dwordx4 v[124:127], v9, s[28:31], s53 offen offset:0 nt
    v_mul_f32 v107, v107, v245
    v_cvt_pk_bf16_f32 v104, v104, v105
    v_cvt_pk_bf16_f32 v105, v106, v107
    ds_write_b64 v243, v[104:105] offset:4096
    ds_read_b128 v[128:131], v244 offset:4096
    ds_read_b64 v[132:133], v244 offset:5128
    ds_read_b64 v[134:135], v244 offset:5120
    v_mul_f32 v84, v84, v246
    v_mul_f32 v85, v85, v246
    v_mul_f32 v86, v86, v246
    v_mul_f32 v87, v87, v246
    v_cvt_pk_bf16_f32 v84, v84, v85
    v_cvt_pk_bf16_f32 v85, v86, v87
    ds_write_b64 v240, v[84:85] offset:6144
    v_mul_f32 v92, v92, v246
    v_mul_f32 v93, v93, v246
    v_mul_f32 v94, v94, v246
    v_mul_f32 v95, v95, v246
    v_cvt_pk_bf16_f32 v92, v92, v93
    v_cvt_pk_bf16_f32 v93, v94, v95
    ds_write_b64 v241, v[92:93] offset:6144
    v_mul_f32 v100, v100, v246
    v_mul_f32 v101, v101, v246
    v_mul_f32 v102, v102, v246
    v_mul_f32 v103, v103, v246
    s_waitcnt lgkmcnt(4)
    buffer_store_dwordx4 v[128:131], v9, s[28:31], s46 offen offset:128 nt
    v_cvt_pk_bf16_f32 v100, v100, v101
    v_cvt_pk_bf16_f32 v101, v102, v103
    ds_write_b64 v242, v[100:101] offset:6144
    v_mul_f32 v108, v108, v246
    v_mul_f32 v109, v109, v246
    v_mul_f32 v110, v110, v246
    s_waitcnt lgkmcnt(3)
    buffer_store_dwordx4 v[132:135], v9, s[28:31], s47 offen offset:128 nt
    v_mul_f32 v111, v111, v246
    v_cvt_pk_bf16_f32 v108, v108, v109
    v_cvt_pk_bf16_f32 v109, v110, v111
    ds_write_b64 v243, v[108:109] offset:6144
    ds_read_b128 v[136:139], v244 offset:6144
    ds_read_b64 v[140:141], v244 offset:7176
    ds_read_b64 v[142:143], v244 offset:7168
    s_waitcnt lgkmcnt(2)
    buffer_store_dwordx4 v[136:139], v9, s[28:31], s48 offen offset:128 nt
    s_waitcnt lgkmcnt(0)
    buffer_store_dwordx4 v[140:143], v9, s[28:31], s53 offen offset:128 nt
    s_branch L_fin
L_retR0:
    s_waitcnt vmcnt(10) lgkmcnt(0)
    s_barrier
    v_mfma_f32_16x16x32_bf16 v[128:131], v[160:163], v[16:19], v[224:227]
    ds_read_b64_tr_b16 v[192:193], v6 offset:0
    ds_read_b64_tr_b16 v[194:195], v6 offset:512
    v_exp_f32 v236, v112
    v_exp_f32 v237, v113
    v_mfma_f32_16x16x32_bf16 v[136:139], v[160:163], v[32:35], v[228:231]
    ds_read_b64_tr_b16 v[196:197], v6 offset:32
    ds_read_b64_tr_b16 v[198:199], v6 offset:544
    v_add_f32 v232, v234, v236
    v_cvt_pk_bf16_f32 v144, v236, v237
    v_mfma_f32_16x16x32_bf16 v[128:131], v[164:167], v[20:23], v[128:131]
    ds_read_b64_tr_b16 v[200:201], v6 offset:64
    ds_read_b64_tr_b16 v[202:203], v6 offset:576
    v_exp_f32 v238, v114
    v_mfma_f32_16x16x32_bf16 v[136:139], v[164:167], v[36:39], v[136:139]
    ds_read_b64_tr_b16 v[204:205], v6 offset:96
    ds_read_b64_tr_b16 v[206:207], v6 offset:608
    v_exp_f32 v239, v115
    v_add_f32 v232, v232, v237
    v_add_f32 v232, v232, v238
    v_mfma_f32_16x16x32_bf16 v[128:131], v[168:171], v[24:27], v[128:131]
    ds_read_b64_tr_b16 v[208:209], v6 offset:128
    ds_read_b64_tr_b16 v[210:211], v6 offset:640
    v_add_f32 v232, v232, v239
    v_cvt_pk_bf16_f32 v145, v238, v239
    v_mfma_f32_16x16x32_bf16 v[136:139], v[168:171], v[40:43], v[136:139]
    ds_read_b64_tr_b16 v[212:213], v6 offset:160
    ds_read_b64_tr_b16 v[214:215], v6 offset:672
    v_exp_f32 v236, v116
    v_mfma_f32_16x16x32_bf16 v[128:131], v[172:175], v[28:31], v[128:131]
    ds_read_b64_tr_b16 v[216:217], v6 offset:192
    ds_read_b64_tr_b16 v[218:219], v6 offset:704
    v_exp_f32 v237, v117
    v_mfma_f32_16x16x32_bf16 v[136:139], v[172:175], v[44:47], v[136:139]
    ds_read_b64_tr_b16 v[220:221], v6 offset:224
    ds_read_b64_tr_b16 v[222:223], v6 offset:736
    v_add_f32 v232, v232, v236
    v_cvt_pk_bf16_f32 v146, v236, v237
    v_exp_f32 v238, v118
    s_waitcnt lgkmcnt(8)
    v_mfma_f32_16x16x32_bf16 v[48:51], v[192:195], v[152:155], v[48:51]
    v_exp_f32 v239, v119
    v_mfma_f32_16x16x32_bf16 v[52:55], v[192:195], v[156:159], v[52:55]
    v_add_f32 v232, v232, v237
    v_add_f32 v232, v232, v238
    v_mfma_f32_16x16x32_bf16 v[60:63], v[196:199], v[156:159], v[60:63]
    v_add_f32 v232, v232, v239
    v_cvt_pk_bf16_f32 v147, v238, v239
    v_mfma_f32_16x16x32_bf16 v[56:59], v[196:199], v[152:155], v[56:59]
    v_exp_f32 v236, v120
    v_exp_f32 v237, v121
    v_mfma_f32_16x16x32_bf16 v[64:67], v[200:203], v[152:155], v[64:67]
    v_add_f32 v233, v235, v236
    v_cvt_pk_bf16_f32 v148, v236, v237
    v_mfma_f32_16x16x32_bf16 v[68:71], v[200:203], v[156:159], v[68:71]
    s_add_u32 m0, s39, s38
    v_exp_f32 v238, v122
    v_mfma_f32_16x16x32_bf16 v[76:79], v[204:207], v[156:159], v[76:79]
    buffer_load_dwordx4 v1, s[24:27], s34 offen lds
    v_exp_f32 v239, v123
    v_add_f32 v233, v233, v237
    v_add_f32 v233, v233, v238
    v_mfma_f32_16x16x32_bf16 v[72:75], v[204:207], v[152:155], v[72:75]
    s_xor_b32 s38, s38, 0x4200
    v_add_f32 v233, v233, v239
    v_cvt_pk_bf16_f32 v149, v238, v239
    s_waitcnt lgkmcnt(0)
    v_mfma_f32_16x16x32_bf16 v[80:83], v[208:211], v[152:155], v[80:83]
    v_exp_f32 v236, v124
    v_mfma_f32_16x16x32_bf16 v[84:87], v[208:211], v[156:159], v[84:87]
    buffer_load_dwordx4 v2, s[24:27], s34 offen offset:1056 lds
    v_exp_f32 v237, v125
    v_mfma_f32_16x16x32_bf16 v[92:95], v[212:215], v[156:159], v[92:95]
    s_add_u32 m0, s40, s36
    v_add_f32 v233, v233, v236
    v_cvt_pk_bf16_f32 v150, v236, v237
    v_exp_f32 v238, v126
    v_mfma_f32_16x16x32_bf16 v[88:91], v[212:215], v[152:155], v[88:91]
    buffer_load_dwordx4 v1, s[20:23], s33 offen lds
    v_exp_f32 v239, v127
    v_mfma_f32_16x16x32_bf16 v[96:99], v[216:219], v[152:155], v[96:99]
    s_add_u32 s34, s34, 131072
    v_add_f32 v233, v233, v237
    v_add_f32 v233, v233, v238
    v_mfma_f32_16x16x32_bf16 v[100:103], v[216:219], v[156:159], v[100:103]
    v_add_f32 v233, v233, v239
    v_cvt_pk_bf16_f32 v151, v238, v239
    v_mfma_f32_16x16x32_bf16 v[108:111], v[220:223], v[156:159], v[108:111]
    buffer_load_dwordx4 v2, s[20:23], s33 offen offset:1056 lds
    s_add_u32 s36, s35, 8448
    s_cselect_b32 s36, 0xffff5b00, s36
    v_max_f32 v11, v232, v233
    v_cmp_lt_f32 vcc, s52, v11
    v_mfma_f32_16x16x32_bf16 v[104:107], v[220:223], v[152:155], v[104:107]
    s_add_u32 s33, s33, 131072
    v_add_u32 v6, s38, v4
    s_cbranch_vccnz L_fbR0
L_fbretR0:
L_tailR1:
    s_cmp_eq_u32 s19, 0
    s_cbranch_scc1 L_tailER1
    s_add_u32 m0, s39, s37
    s_bfe_u32 s45, s15, 0x80008
    v_lshrrev_b32 v11, 4, v10
    v_lshlrev_b32 v11, 2, v11
    v_sub_u32 v11, s45, v11
    v_mov_b32 v12, 0xff800000
    s_waitcnt vmcnt(10) lgkmcnt(0)
    s_barrier
    ds_read_b64_tr_b16 v[192:193], v6 offset:0
    ds_read_b64_tr_b16 v[194:195], v6 offset:512
    v_cmp_lt_i32 s[54:55], 0, v11
    v_cmp_lt_i32 s[56:57], 1, v11
    v_cmp_lt_i32 s[58:59], 2, v11
    ds_read_b64_tr_b16 v[196:197], v6 offset:32
    ds_read_b64_tr_b16 v[198:199], v6 offset:544
    v_cmp_lt_i32 s[60:61], 3, v11
    v_cndmask_b32 v128, v12, v128, s[54:55]
    v_cndmask_b32 v129, v12, v129, s[56:57]
    ds_read_b64_tr_b16 v[200:201], v6 offset:64
    ds_read_b64_tr_b16 v[202:203], v6 offset:576
    v_cndmask_b32 v130, v12, v130, s[58:59]
    v_cndmask_b32 v131, v12, v131, s[60:61]
    v_cndmask_b32 v136, v12, v136, s[54:55]
    ds_read_b64_tr_b16 v[204:205], v6 offset:96
    ds_read_b64_tr_b16 v[206:207], v6 offset:608
    v_cndmask_b32 v137, v12, v137, s[56:57]
    v_cndmask_b32 v138, v12, v138, s[58:59]
    v_cndmask_b32 v139, v12, v139, s[60:61]
    s_waitcnt lgkmcnt(6)
    v_mfma_f32_16x16x32_bf16 v[48:51], v[192:195], v[144:147], v[48:51]
    ds_read_b64_tr_b16 v[208:209], v6 offset:128
    v_exp_f32 v236, v128
    v_mfma_f32_16x16x32_bf16 v[52:55], v[192:195], v[148:151], v[52:55]
    ds_read_b64_tr_b16 v[210:211], v6 offset:640
    v_exp_f32 v237, v129
    v_add_f32 v234, v232, v236
    s_waitcnt lgkmcnt(6)
    v_mfma_f32_16x16x32_bf16 v[60:63], v[196:199], v[148:151], v[60:63]
    ds_read_b64_tr_b16 v[212:213], v6 offset:160
    v_exp_f32 v238, v130
    v_add_f32 v234, v234, v237
    v_cvt_pk_bf16_f32 v152, v236, v237
    v_mfma_f32_16x16x32_bf16 v[56:59], v[196:199], v[144:147], v[56:59]
    ds_read_b64_tr_b16 v[214:215], v6 offset:672
    v_exp_f32 v239, v131
    v_add_f32 v234, v234, v238
    s_waitcnt lgkmcnt(6)
    v_mfma_f32_16x16x32_bf16 v[64:67], v[200:203], v[144:147], v[64:67]
    ds_read_b64_tr_b16 v[216:217], v6 offset:192
    v_exp_f32 v236, v136
    v_add_f32 v234, v234, v239
    v_cvt_pk_bf16_f32 v153, v238, v239
    v_mfma_f32_16x16x32_bf16 v[68:71], v[200:203], v[148:151], v[68:71]
    ds_read_b64_tr_b16 v[218:219], v6 offset:704
    v_exp_f32 v237, v137
    v_add_f32 v235, v233, v236
    s_waitcnt lgkmcnt(6)
    v_mfma_f32_16x16x32_bf16 v[76:79], v[204:207], v[148:151], v[76:79]
    ds_read_b64_tr_b16 v[220:221], v6 offset:224
    v_exp_f32 v238, v138
    v_add_f32 v235, v235, v237
    v_cvt_pk_bf16_f32 v156, v236, v237
    v_mfma_f32_16x16x32_bf16 v[72:75], v[204:207], v[144:147], v[72:75]
    ds_read_b64_tr_b16 v[222:223], v6 offset:736
    v_exp_f32 v239, v139
    v_add_f32 v235, v235, v238
    s_waitcnt lgkmcnt(6)
    v_mfma_f32_16x16x32_bf16 v[80:83], v[208:211], v[144:147], v[80:83]
    buffer_load_dwordx4 v1, s[24:27], s34 offen lds
    v_add_f32 v235, v235, v239
    v_cvt_pk_bf16_f32 v157, v238, v239
    v_mfma_f32_16x16x32_bf16 v[84:87], v[208:211], v[148:151], v[84:87]
    s_xor_b32 s37, s37, 0x4200
    s_waitcnt lgkmcnt(4)
    v_mfma_f32_16x16x32_bf16 v[92:95], v[212:215], v[148:151], v[92:95]
    s_sub_u32 s43, s35, 8448
    v_mov_b32 v154, 0
    v_mov_b32 v155, 0
    v_mfma_f32_16x16x32_bf16 v[88:91], v[212:215], v[144:147], v[88:91]
    s_cmp_lt_u32 s43, 0xffff5b00
    s_waitcnt lgkmcnt(2)
    v_mfma_f32_16x16x32_bf16 v[96:99], v[216:219], v[144:147], v[96:99]
    s_cselect_b32 s43, 0xffffdf00, s43
    v_mov_b32 v158, 0
    v_mov_b32 v159, 0
    v_mfma_f32_16x16x32_bf16 v[100:103], v[216:219], v[148:151], v[100:103]
    buffer_load_dwordx4 v2, s[24:27], s34 offen offset:1056 lds
    s_waitcnt lgkmcnt(0)
    v_mfma_f32_16x16x32_bf16 v[108:111], v[220:223], v[148:151], v[108:111]
    s_mov_b32 s44, s38
    v_mfma_f32_16x16x32_bf16 v[104:107], v[220:223], v[144:147], v[104:107]
    s_add_u32 s34, s34, 131072
    v_add_u32 v6, s37, v4
    v_max_f32 v11, v234, v235
    v_cmp_lt_f32 vcc, s52, v11
    s_cmp_eq_u32 s19, 0
    s_cbranch_vccnz L_fbTR1
    s_branch L_fbretT1
L_tailER1:
    s_xor_b32 s46, s37, 0x4200
    s_bfe_u32 s45, s15, 0x80008
    v_lshrrev_b32 v11, 4, v10
    v_lshlrev_b32 v11, 2, v11
    v_sub_u32 v11, s45, v11
    v_mov_b32 v12, 0xff800000
    v_add_u32 v247, s46, v4
    s_waitcnt vmcnt(6) lgkmcnt(0)
    s_barrier
    ds_read_b64_tr_b16 v[192:193], v6 offset:0
    ds_read_b64_tr_b16 v[194:195], v6 offset:512
    v_cmp_lt_i32 s[54:55], 0, v11
    v_cmp_lt_i32 s[56:57], 1, v11
    v_cmp_lt_i32 s[58:59], 2, v11
    ds_read_b64_tr_b16 v[196:197], v6 offset:32
    ds_read_b64_tr_b16 v[198:199], v6 offset:544
    v_cmp_lt_i32 s[60:61], 3, v11
    v_cndmask_b32 v128, v12, v128, s[54:55]
    v_cndmask_b32 v129, v12, v129, s[56:57]
    ds_read_b64_tr_b16 v[200:201], v6 offset:64
    ds_read_b64_tr_b16 v[202:203], v6 offset:576
    v_cndmask_b32 v130, v12, v130, s[58:59]
    v_cndmask_b32 v131, v12, v131, s[60:61]
    v_cndmask_b32 v136, v12, v136, s[54:55]
    ds_read_b64_tr_b16 v[204:205], v6 offset:96
    ds_read_b64_tr_b16 v[206:207], v6 offset:608
    v_cndmask_b32 v137, v12, v137, s[56:57]
    v_cndmask_b32 v138, v12, v138, s[58:59]
    v_cndmask_b32 v139, v12, v139, s[60:61]
    s_waitcnt lgkmcnt(6)
    v_mfma_f32_16x16x32_bf16 v[48:51], v[192:195], v[144:147], v[48:51]
    v_exp_f32 v236, v128
    ds_read_b64_tr_b16 v[208:209], v6 offset:128
    s_add_u32 s43, s36, 8448
    s_cselect_b32 s43, 0xffff5b00, s43
    v_mfma_f32_16x16x32_bf16 v[52:55], v[192:195], v[148:151], v[52:55]
    v_exp_f32 v237, v129
    ds_read_b64_tr_b16 v[210:211], v6 offset:640
    s_cmp_eq_u32 s32, 1
    s_cselect_b32 s43, s36, s43
    v_add_f32 v234, v232, v236
    s_waitcnt lgkmcnt(6)
    v_mfma_f32_16x16x32_bf16 v[60:63], v[196:199], v[148:151], v[60:63]
    v_exp_f32 v238, v130
    ds_read_b64_tr_b16 v[212:213], v6 offset:160
    s_cmp_eq_u32 s32, 0
    s_cselect_b32 s43, s35, s43
    v_add_f32 v234, v234, v237
    v_cvt_pk_bf16_f32 v152, v236, v237
    v_mfma_f32_16x16x32_bf16 v[56:59], v[196:199], v[144:147], v[56:59]
    v_exp_f32 v239, v131
    ds_read_b64_tr_b16 v[214:215], v6 offset:672
    s_add_u32 s43, s43, 76032
    s_cmp_eq_u32 s32, 3
    v_add_f32 v234, v234, v238
    s_waitcnt lgkmcnt(6)
    v_mfma_f32_16x16x32_bf16 v[64:67], v[200:203], v[144:147], v[64:67]
    v_exp_f32 v236, v136
    ds_read_b64_tr_b16 v[216:217], v6 offset:192
    s_cselect_b32 s43, s37, s43
    s_and_b32 s45, s32, 1
    v_add_f32 v234, v234, v239
    v_cvt_pk_bf16_f32 v153, v238, v239
    v_mfma_f32_16x16x32_bf16 v[68:71], v[200:203], v[148:151], v[68:71]
    v_exp_f32 v237, v137
    ds_read_b64_tr_b16 v[218:219], v6 offset:704
    s_lshl_b32 s45, s45, 12
    s_sub_u32 s45, s43, s45
    v_add_f32 v235, v233, v236
    s_waitcnt lgkmcnt(6)
    v_mfma_f32_16x16x32_bf16 v[76:79], v[204:207], v[148:151], v[76:79]
    v_exp_f32 v238, v138
    ds_read_b64_tr_b16 v[220:221], v6 offset:224
    s_add_u32 s46, s3, s13
    s_mov_b32 s30, s14
    v_add_f32 v235, v235, v237
    v_cvt_pk_bf16_f32 v156, v236, v237
    v_mfma_f32_16x16x32_bf16 v[72:75], v[204:207], v[144:147], v[72:75]
    v_exp_f32 v239, v139
    ds_read_b64_tr_b16 v[222:223], v6 offset:736
    s_add_u32 s47, s46, 32768
    s_add_u32 s48, s46, 65536
    v_add_f32 v235, v235, v238
    s_waitcnt lgkmcnt(6)
    v_mfma_f32_16x16x32_bf16 v[80:83], v[208:211], v[144:147], v[80:83]
    v_add_f32 v235, v235, v239
    ds_read_b64_tr_b16 v[160:161], v247 offset:0
    ds_read_b64_tr_b16 v[162:163], v247 offset:512
    s_add_u32 s53, s46, 98304
    v_cvt_pk_bf16_f32 v157, v238, v239
    v_mfma_f32_16x16x32_bf16 v[84:87], v[208:211], v[148:151], v[84:87]
    v_add_u32 v240, s45, v7
    ds_read_b64_tr_b16 v[164:165], v247 offset:32
    ds_read_b64_tr_b16 v[166:167], v247 offset:544
    s_waitcnt lgkmcnt(8)
    v_mfma_f32_16x16x32_bf16 v[92:95], v[212:215], v[148:151], v[92:95]
    v_mov_b32 v154, 0
    ds_read_b64_tr_b16 v[168:169], v247 offset:64
    ds_read_b64_tr_b16 v[170:171], v247 offset:576
    v_mov_b32 v155, 0
    v_mfma_f32_16x16x32_bf16 v[88:91], v[212:215], v[144:147], v[88:91]
    v_add_u32 v244, s45, v8
    ds_read_b64_tr_b16 v[172:173], v247 offset:96
    ds_read_b64_tr_b16 v[174:175], v247 offset:608
    s_waitcnt lgkmcnt(10)
    v_mfma_f32_16x16x32_bf16 v[96:99], v[216:219], v[144:147], v[96:99]
    v_mov_b32 v158, 0
    ds_read_b64_tr_b16 v[176:177], v247 offset:128
    ds_read_b64_tr_b16 v[178:179], v247 offset:640
    v_mov_b32 v159, 0
    v_mfma_f32_16x16x32_bf16 v[100:103], v[216:219], v[148:151], v[100:103]
    v_xor_b32 v241, 32, v240
    ds_read_b64_tr_b16 v[180:181], v247 offset:160
    ds_read_b64_tr_b16 v[182:183], v247 offset:672
    s_waitcnt lgkmcnt(12)
    v_mfma_f32_16x16x32_bf16 v[108:111], v[220:223], v[148:151], v[108:111]
    ds_read_b64_tr_b16 v[184:185], v247 offset:192
    ds_read_b64_tr_b16 v[186:187], v247 offset:704
    v_mfma_f32_16x16x32_bf16 v[104:107], v[220:223], v[144:147], v[104:107]
    v_xor_b32 v242, 64, v240
    ds_read_b64_tr_b16 v[188:189], v247 offset:224
    ds_read_b64_tr_b16 v[190:191], v247 offset:736
    v_xor_b32 v243, 96, v240
    v_max_f32 v11, v234, v235
    v_cmp_lt_f32 vcc, s52, v11
    s_cmp_eq_u32 s19, 0
    s_cbranch_vccnz L_fbTR1
    s_branch L_fbretE1
L_retR1:
    s_waitcnt vmcnt(10) lgkmcnt(0)
    s_barrier
    v_mfma_f32_16x16x32_bf16 v[112:115], v[160:163], v[16:19], v[224:227]
    ds_read_b64_tr_b16 v[192:193], v6 offset:0
    ds_read_b64_tr_b16 v[194:195], v6 offset:512
    v_exp_f32 v236, v128
    v_exp_f32 v237, v129
    v_mfma_f32_16x16x32_bf16 v[120:123], v[160:163], v[32:35], v[228:231]
    ds_read_b64_tr_b16 v[196:197], v6 offset:32
    ds_read_b64_tr_b16 v[198:199], v6 offset:544
    v_add_f32 v234, v232, v236
    v_cvt_pk_bf16_f32 v152, v236, v237
    v_mfma_f32_16x16x32_bf16 v[112:115], v[164:167], v[20:23], v[112:115]
    ds_read_b64_tr_b16 v[200:201], v6 offset:64
    ds_read_b64_tr_b16 v[202:203], v6 offset:576
    v_exp_f32 v238, v130
    v_mfma_f32_16x16x32_bf16 v[120:123], v[164:167], v[36:39], v[120:123]
    ds_read_b64_tr_b16 v[204:205], v6 offset:96
    ds_read_b64_tr_b16 v[206:207], v6 offset:608
    v_exp_f32 v239, v131
    v_add_f32 v234, v234, v237
    v_add_f32 v234, v234, v238
    v_mfma_f32_16x16x32_bf16 v[112:115], v[168:171], v[24:27], v[112:115]
    ds_read_b64_tr_b16 v[208:209], v6 offset:128
    ds_read_b64_tr_b16 v[210:211], v6 offset:640
    v_add_f32 v234, v234, v239
    v_cvt_pk_bf16_f32 v153, v238, v239
    v_mfma_f32_16x16x32_bf16 v[120:123], v[168:171], v[40:43], v[120:123]
    ds_read_b64_tr_b16 v[212:213], v6 offset:160
    ds_read_b64_tr_b16 v[214:215], v6 offset:672
    v_exp_f32 v236, v132
    v_mfma_f32_16x16x32_bf16 v[112:115], v[172:175], v[28:31], v[112:115]
    ds_read_b64_tr_b16 v[216:217], v6 offset:192
    ds_read_b64_tr_b16 v[218:219], v6 offset:704
    v_exp_f32 v237, v133
    v_mfma_f32_16x16x32_bf16 v[120:123], v[172:175], v[44:47], v[120:123]
    ds_read_b64_tr_b16 v[220:221], v6 offset:224
    ds_read_b64_tr_b16 v[222:223], v6 offset:736
    v_add_f32 v234, v234, v236
    v_cvt_pk_bf16_f32 v154, v236, v237
    v_exp_f32 v238, v134
    s_waitcnt lgkmcnt(8)
    v_mfma_f32_16x16x32_bf16 v[48:51], v[192:195], v[144:147], v[48:51]
    v_exp_f32 v239, v135
    v_mfma_f32_16x16x32_bf16 v[52:55], v[192:195], v[148:151], v[52:55]
    v_add_f32 v234, v234, v237
    v_add_f32 v234, v234, v238
    v_mfma_f32_16x16x32_bf16 v[60:63], v[196:199], v[148:151], v[60:63]
    v_add_f32 v234, v234, v239
    v_cvt_pk_bf16_f32 v155, v238, v239
    v_mfma_f32_16x16x32_bf16 v[56:59], v[196:199], v[144:147], v[56:59]
    v_exp_f32 v236, v136
    v_exp_f32 v237, v137
    v_mfma_f32_16x16x32_bf16 v[64:67], v[200:203], v[144:147], v[64:67]
    v_add_f32 v235, v233, v236
    v_cvt_pk_bf16_f32 v156, v236, v237
    v_mfma_f32_16x16x32_bf16 v[68:71], v[200:203], v[148:151], v[68:71]
    s_add_u32 m0, s39, s37
    v_exp_f32 v238, v138
    v_mfma_f32_16x16x32_bf16 v[76:79], v[204:207], v[148:151], v[76:79]
    buffer_load_dwordx4 v1, s[24:27], s34 offen lds
    v_exp_f32 v239, v139
    v_add_f32 v235, v235, v237
    v_add_f32 v235, v235, v238
    v_mfma_f32_16x16x32_bf16 v[72:75], v[204:207], v[144:147], v[72:75]
    s_xor_b32 s37, s37, 0x4200
    v_add_f32 v235, v235, v239
    v_cvt_pk_bf16_f32 v157, v238, v239
    s_waitcnt lgkmcnt(0)
    v_mfma_f32_16x16x32_bf16 v[80:83], v[208:211], v[144:147], v[80:83]
    v_exp_f32 v236, v140
    v_mfma_f32_16x16x32_bf16 v[84:87], v[208:211], v[148:151], v[84:87]
    buffer_load_dwordx4 v2, s[24:27], s34 offen offset:1056 lds
    v_exp_f32 v237, v141
    v_mfma_f32_16x16x32_bf16 v[92:95], v[212:215], v[148:151], v[92:95]
    s_add_u32 m0, s40, s35
    v_add_f32 v235, v235, v236
    v_cvt_pk_bf16_f32 v158, v236, v237
    v_exp_f32 v238, v142
    v_mfma_f32_16x16x32_bf16 v[88:91], v[212:215], v[144:147], v[88:91]
    buffer_load_dwordx4 v1, s[20:23], s33 offen lds
    v_exp_f32 v239, v143
    v_mfma_f32_16x16x32_bf16 v[96:99], v[216:219], v[144:147], v[96:99]
    s_add_u32 s34, s34, 131072
    v_add_f32 v235, v235, v237
    v_add_f32 v235, v235, v238
    v_mfma_f32_16x16x32_bf16 v[100:103], v[216:219], v[148:151], v[100:103]
    v_add_f32 v235, v235, v239
    v_cvt_pk_bf16_f32 v159, v238, v239
    v_mfma_f32_16x16x32_bf16 v[108:111], v[220:223], v[148:151], v[108:111]
    buffer_load_dwordx4 v2, s[20:23], s33 offen offset:1056 lds
    s_add_u32 s35, s36, 8448
    s_cselect_b32 s35, 0xffff5b00, s35
    v_max_f32 v11, v234, v235
    v_cmp_lt_f32 vcc, s52, v11
    v_mfma_f32_16x16x32_bf16 v[104:107], v[220:223], v[144:147], v[104:107]
    s_add_u32 s33, s33, 131072
    v_add_u32 v6, s37, v4
    s_cbranch_vccnz L_fbR1
L_fbretR1:
L_tailR0:
    s_cmp_eq_u32 s19, 0
    s_cbranch_scc1 L_tailER0
    s_add_u32 m0, s39, s38
    s_bfe_u32 s45, s15, 0x80008
    v_lshrrev_b32 v11, 4, v10
    v_lshlrev_b32 v11, 2, v11
    v_sub_u32 v11, s45, v11
    v_mov_b32 v12, 0xff800000
    s_waitcnt vmcnt(10) lgkmcnt(0)
    s_barrier
    ds_read_b64_tr_b16 v[192:193], v6 offset:0
    ds_read_b64_tr_b16 v[194:195], v6 offset:512
    v_cmp_lt_i32 s[54:55], 0, v11
    v_cmp_lt_i32 s[56:57], 1, v11
    v_cmp_lt_i32 s[58:59], 2, v11
    ds_read_b64_tr_b16 v[196:197], v6 offset:32
    ds_read_b64_tr_b16 v[198:199], v6 offset:544
    v_cmp_lt_i32 s[60:61], 3, v11
    v_cndmask_b32 v112, v12, v112, s[54:55]
    v_cndmask_b32 v113, v12, v113, s[56:57]
    ds_read_b64_tr_b16 v[200:201], v6 offset:64
    ds_read_b64_tr_b16 v[202:203], v6 offset:576
    v_cndmask_b32 v114, v12, v114, s[58:59]
    v_cndmask_b32 v115, v12, v115, s[60:61]
    v_cndmask_b32 v120, v12, v120, s[54:55]
    ds_read_b64_tr_b16 v[204:205], v6 offset:96
    ds_read_b64_tr_b16 v[206:207], v6 offset:608
    v_cndmask_b32 v121, v12, v121, s[56:57]
    v_cndmask_b32 v122, v12, v122, s[58:59]
    v_cndmask_b32 v123, v12, v123, s[60:61]
    s_waitcnt lgkmcnt(6)
    v_mfma_f32_16x16x32_bf16 v[48:51], v[192:195], v[152:155], v[48:51]
    ds_read_b64_tr_b16 v[208:209], v6 offset:128
    v_exp_f32 v236, v112
    v_mfma_f32_16x16x32_bf16 v[52:55], v[192:195], v[156:159], v[52:55]
    ds_read_b64_tr_b16 v[210:211], v6 offset:640
    v_exp_f32 v237, v113
    v_add_f32 v232, v234, v236
    s_waitcnt lgkmcnt(6)
    v_mfma_f32_16x16x32_bf16 v[60:63], v[196:199], v[156:159], v[60:63]
    ds_read_b64_tr_b16 v[212:213], v6 offset:160
    v_exp_f32 v238, v114
    v_add_f32 v232, v232, v237
    v_cvt_pk_bf16_f32 v144, v236, v237
    v_mfma_f32_16x16x32_bf16 v[56:59], v[196:199], v[152:155], v[56:59]
    ds_read_b64_tr_b16 v[214:215], v6 offset:672
    v_exp_f32 v239, v115
    v_add_f32 v232, v232, v238
    s_waitcnt lgkmcnt(6)
    v_mfma_f32_16x16x32_bf16 v[64:67], v[200:203], v[152:155], v[64:67]
    ds_read_b64_tr_b16 v[216:217], v6 offset:192
    v_exp_f32 v236, v120
    v_add_f32 v232, v232, v239
    v_cvt_pk_bf16_f32 v145, v238, v239
    v_mfma_f32_16x16x32_bf16 v[68:71], v[200:203], v[156:159], v[68:71]
    ds_read_b64_tr_b16 v[218:219], v6 offset:704
    v_exp_f32 v237, v121
    v_add_f32 v233, v235, v236
    s_waitcnt lgkmcnt(6)
    v_mfma_f32_16x16x32_bf16 v[76:79], v[204:207], v[156:159], v[76:79]
    ds_read_b64_tr_b16 v[220:221], v6 offset:224
    v_exp_f32 v238, v122
    v_add_f32 v233, v233, v237
    v_cvt_pk_bf16_f32 v148, v236, v237
    v_mfma_f32_16x16x32_bf16 v[72:75], v[204:207], v[152:155], v[72:75]
    ds_read_b64_tr_b16 v[222:223], v6 offset:736
    v_exp_f32 v239, v123
    v_add_f32 v233, v233, v238
    s_waitcnt lgkmcnt(6)
    v_mfma_f32_16x16x32_bf16 v[80:83], v[208:211], v[152:155], v[80:83]
    buffer_load_dwordx4 v1, s[24:27], s34 offen lds
    v_add_f32 v233, v233, v239
    v_cvt_pk_bf16_f32 v149, v238, v239
    v_mfma_f32_16x16x32_bf16 v[84:87], v[208:211], v[156:159], v[84:87]
    s_xor_b32 s38, s38, 0x4200
    s_waitcnt lgkmcnt(4)
    v_mfma_f32_16x16x32_bf16 v[92:95], v[212:215], v[156:159], v[92:95]
    s_sub_u32 s43, s36, 8448
    v_mov_b32 v146, 0
    v_mov_b32 v147, 0
    v_mfma_f32_16x16x32_bf16 v[88:91], v[212:215], v[152:155], v[88:91]
    s_cmp_lt_u32 s43, 0xffff5b00
    s_waitcnt lgkmcnt(2)
    v_mfma_f32_16x16x32_bf16 v[96:99], v[216:219], v[152:155], v[96:99]
    s_cselect_b32 s43, 0xffffdf00, s43
    v_mov_b32 v150, 0
    v_mov_b32 v151, 0
    v_mfma_f32_16x16x32_bf16 v[100:103], v[216:219], v[156:159], v[100:103]
    buffer_load_dwordx4 v2, s[24:27], s34 offen offset:1056 lds
    s_waitcnt lgkmcnt(0)
    v_mfma_f32_16x16x32_bf16 v[108:111], v[220:223], v[156:159], v[108:111]
    s_mov_b32 s44, s37
    v_mfma_f32_16x16x32_bf16 v[104:107], v[220:223], v[152:155], v[104:107]
    s_add_u32 s34, s34, 131072
    v_add_u32 v6, s38, v4
    v_max_f32 v11, v232, v233
    v_cmp_lt_f32 vcc, s52, v11
    s_mov_b32 s37, s38
    s_cmp_eq_u32 s19, 0
    s_cbranch_vccnz L_fbTR0
    s_branch L_fbretT0
L_tailER0:
    s_xor_b32 s46, s38, 0x4200
    s_bfe_u32 s45, s15, 0x80008
    v_lshrrev_b32 v11, 4, v10
    v_lshlrev_b32 v11, 2, v11
    v_sub_u32 v11, s45, v11
    v_mov_b32 v12, 0xff800000
    v_add_u32 v247, s46, v4
    s_waitcnt vmcnt(6) lgkmcnt(0)
    s_barrier
    ds_read_b64_tr_b16 v[192:193], v6 offset:0
    ds_read_b64_tr_b16 v[194:195], v6 offset:512
    v_cmp_lt_i32 s[54:55], 0, v11
    v_cmp_lt_i32 s[56:57], 1, v11
    v_cmp_lt_i32 s[58:59], 2, v11
    ds_read_b64_tr_b16 v[196:197], v6 offset:32
    ds_read_b64_tr_b16 v[198:199], v6 offset:544
    v_cmp_lt_i32 s[60:61], 3, v11
    v_cndmask_b32 v112, v12, v112, s[54:55]
    v_cndmask_b32 v113, v12, v113, s[56:57]
    ds_read_b64_tr_b16 v[200:201], v6 offset:64
    ds_read_b64_tr_b16 v[202:203], v6 offset:576
    v_cndmask_b32 v114, v12, v114, s[58:59]
    v_cndmask_b32 v115, v12, v115, s[60:61]
    v_cndmask_b32 v120, v12, v120, s[54:55]
    ds_read_b64_tr_b16 v[204:205], v6 offset:96
    ds_read_b64_tr_b16 v[206:207], v6 offset:608
    v_cndmask_b32 v121, v12, v121, s[56:57]
    v_cndmask_b32 v122, v12, v122, s[58:59]
    v_cndmask_b32 v123, v12, v123, s[60:61]
    s_waitcnt lgkmcnt(6)
    v_mfma_f32_16x16x32_bf16 v[48:51], v[192:195], v[152:155], v[48:51]
    v_exp_f32 v236, v112
    ds_read_b64_tr_b16 v[208:209], v6 offset:128
    s_add_u32 s43, s35, 8448
    s_cselect_b32 s43, 0xffff5b00, s43
    v_mfma_f32_16x16x32_bf16 v[52:55], v[192:195], v[156:159], v[52:55]
    v_exp_f32 v237, v113
    ds_read_b64_tr_b16 v[210:211], v6 offset:640
    s_cmp_eq_u32 s32, 1
    s_cselect_b32 s43, s35, s43
    v_add_f32 v232, v234, v236
    s_waitcnt lgkmcnt(6)
    v_mfma_f32_16x16x32_bf16 v[60:63], v[196:199], v[156:159], v[60:63]
    v_exp_f32 v238, v114
    ds_read_b64_tr_b16 v[212:213], v6 offset:160
    s_cmp_eq_u32 s32, 0
    s_cselect_b32 s43, s36, s43
    v_add_f32 v232, v232, v237
    v_cvt_pk_bf16_f32 v144, v236, v237
    v_mfma_f32_16x16x32_bf16 v[56:59], v[196:199], v[152:155], v[56:59]
    v_exp_f32 v239, v115
    ds_read_b64_tr_b16 v[214:215], v6 offset:672
    s_add_u32 s43, s43, 76032
    s_cmp_eq_u32 s32, 3
    v_add_f32 v232, v232, v238
    s_waitcnt lgkmcnt(6)
    v_mfma_f32_16x16x32_bf16 v[64:67], v[200:203], v[152:155], v[64:67]
    v_exp_f32 v236, v120
    ds_read_b64_tr_b16 v[216:217], v6 offset:192
    s_cselect_b32 s43, s38, s43
    s_and_b32 s45, s32, 1
    v_add_f32 v232, v232, v239
    v_cvt_pk_bf16_f32 v145, v238, v239
    v_mfma_f32_16x16x32_bf16 v[68:71], v[200:203], v[156:159], v[68:71]
    v_exp_f32 v237, v121
    ds_read_b64_tr_b16 v[218:219], v6 offset:704
    s_lshl_b32 s45, s45, 12
    s_sub_u32 s45, s43, s45
    v_add_f32 v233, v235, v236
    s_waitcnt lgkmcnt(6)
    v_mfma_f32_16x16x32_bf16 v[76:79], v[204:207], v[156:159], v[76:79]
    v_exp_f32 v238, v122
    ds_read_b64_tr_b16 v[220:221], v6 offset:224
    s_add_u32 s46, s3, s13
    s_mov_b32 s30, s14
    v_add_f32 v233, v233, v237
    v_cvt_pk_bf16_f32 v148, v236, v237
    v_mfma_f32_16x16x32_bf16 v[72:75], v[204:207], v[152:155], v[72:75]
    v_exp_f32 v239, v123
    ds_read_b64_tr_b16 v[222:223], v6 offset:736
    s_add_u32 s47, s46, 32768
    s_add_u32 s48, s46, 65536
    v_add_f32 v233, v233, v238
    s_waitcnt lgkmcnt(6)
    v_mfma_f32_16x16x32_bf16 v[80:83], v[208:211], v[152:155], v[80:83]
    v_add_f32 v233, v233, v239
    ds_read_b64_tr_b16 v[160:161], v247 offset:0
    ds_read_b64_tr_b16 v[162:163], v247 offset:512
    s_add_u32 s53, s46, 98304
    v_cvt_pk_bf16_f32 v149, v238, v239
    v_mfma_f32_16x16x32_bf16 v[84:87], v[208:211], v[156:159], v[84:87]
    v_add_u32 v240, s45, v7
    ds_read_b64_tr_b16 v[164:165], v247 offset:32
    ds_read_b64_tr_b16 v[166:167], v247 offset:544
    s_waitcnt lgkmcnt(8)
    v_mfma_f32_16x16x32_bf16 v[92:95], v[212:215], v[156:159], v[92:95]
    v_mov_b32 v146, 0
    ds_read_b64_tr_b16 v[168:169], v247 offset:64
    ds_read_b64_tr_b16 v[170:171], v247 offset:576
    v_mov_b32 v147, 0
    v_mfma_f32_16x16x32_bf16 v[88:91], v[212:215], v[152:155], v[88:91]
    v_add_u32 v244, s45, v8
    ds_read_b64_tr_b16 v[172:173], v247 offset:96
    ds_read_b64_tr_b16 v[174:175], v247 offset:608
    s_waitcnt lgkmcnt(10)
    v_mfma_f32_16x16x32_bf16 v[96:99], v[216:219], v[152:155], v[96:99]
    v_mov_b32 v150, 0
    ds_read_b64_tr_b16 v[176:177], v247 offset:128
    ds_read_b64_tr_b16 v[178:179], v247 offset:640
    v_mov_b32 v151, 0
    v_mfma_f32_16x16x32_bf16 v[100:103], v[216:219], v[156:159], v[100:103]
    v_xor_b32 v241, 32, v240
    ds_read_b64_tr_b16 v[180:181], v247 offset:160
    ds_read_b64_tr_b16 v[182:183], v247 offset:672
    s_waitcnt lgkmcnt(12)
    v_mfma_f32_16x16x32_bf16 v[108:111], v[220:223], v[156:159], v[108:111]
    ds_read_b64_tr_b16 v[184:185], v247 offset:192
    ds_read_b64_tr_b16 v[186:187], v247 offset:704
    v_mfma_f32_16x16x32_bf16 v[104:107], v[220:223], v[152:155], v[104:107]
    v_xor_b32 v242, 64, v240
    ds_read_b64_tr_b16 v[188:189], v247 offset:224
    ds_read_b64_tr_b16 v[190:191], v247 offset:736
    v_xor_b32 v243, 96, v240
    v_max_f32 v11, v232, v233
    v_cmp_lt_f32 vcc, s52, v11
    s_cmp_eq_u32 s19, 0
    s_cbranch_vccnz L_fbTR0
    s_branch L_fbretE0
L_step0I:
    s_add_u32 m0, s40, s43
    s_nop 0
    buffer_load_dwordx4 v1, s[20:23], s33 offen lds
    buffer_load_dwordx4 v2, s[20:23], s33 offen offset:1056 lds
    s_add_u32 s33, s33, 131072
    s_add_u32 s36, s35, 8448
    s_cselect_b32 s36, 0xffff5b00, s36
    s_sub_u32 s41, s41, 1
    s_cbranch_scc1 L_evSI
L_retSxI:
    s_add_u32 m0, s40, s51
    s_nop 0
    v_add_u32 v5, s36, v3
    s_sub_u32 s45, s52, s63
    s_cmp_eq_u32 s62, 0
    s_cbranch_scc1 L_s0wI
    s_waitcnt vmcnt(6)
L_s0wI:
L_fbretSI:
L_retFI:
    s_waitcnt vmcnt(10) lgkmcnt(0)
    s_barrier
    buffer_load_dwordx4 v1, s[20:23], s33 offen lds
    buffer_load_dwordx4 v2, s[20:23], s33 offen offset:1056 lds
    s_add_u32 s33, s33, 131072
    s_sub_u32 s41, s41, 1
    s_cbranch_scc1 L_evFI
L_retFxI:
    s_add_u32 m0, s39, s37
    s_nop 0
    buffer_load_dwordx4 v1, s[24:27], s34 offen lds
    s_xor_b32 s37, s37, 0x4200
    buffer_load_dwordx4 v2, s[24:27], s34 offen offset:1056 lds
    s_add_u32 m0, s40, s35
    s_nop 0
    buffer_load_dwordx4 v1, s[20:23], s33 offen lds
    s_add_u32 s34, s34, 131072
    v_add_u32 v6, s37, v4
    buffer_load_dwordx4 v2, s[20:23], s33 offen offset:1056 lds
    s_add_u32 s35, s36, 8448
    s_cselect_b32 s35, 0xffff5b00, s35
    s_add_u32 s33, s33, 131072
    v_add_u32 v5, s35, v3
    s_sub_u32 s41, s41, 1
L_fbretFI:
    s_cbranch_scc1 L_ev0I
L_ret0I:
    s_waitcnt vmcnt(10) lgkmcnt(0)
    s_barrier
    s_add_u32 m0, s39, s38
    s_nop 0
    buffer_load_dwordx4 v1, s[24:27], s34 offen lds
    s_xor_b32 s38, s38, 0x4200
    buffer_load_dwordx4 v2, s[24:27], s34 offen offset:1056 lds
    s_add_u32 m0, s40, s36
    s_nop 0
    buffer_load_dwordx4 v1, s[20:23], s33 offen lds
    s_add_u32 s34, s34, 131072
    v_add_u32 v6, s38, v4
    buffer_load_dwordx4 v2, s[20:23], s33 offen offset:1056 lds
    s_add_u32 s36, s35, 8448
    s_cselect_b32 s36, 0xffff5b00, s36
    s_add_u32 s33, s33, 131072
    v_add_u32 v5, s36, v3
    s_sub_u32 s41, s41, 1
L_fbret0I:
    s_cbranch_scc1 L_ev1I
L_ret1I:
    s_waitcnt vmcnt(10) lgkmcnt(0)
    s_barrier
    s_add_u32 m0, s39, s37
    s_nop 0
    buffer_load_dwordx4 v1, s[24:27], s34 offen lds
    s_xor_b32 s37, s37, 0x4200
    buffer_load_dwordx4 v2, s[24:27], s34 offen offset:1056 lds
    s_add_u32 m0, s40, s35
    s_nop 0
    buffer_load_dwordx4 v1, s[20:23], s33 offen lds
    s_add_u32 s34, s34, 131072
    v_add_u32 v6, s37, v4
    buffer_load_dwordx4 v2, s[20:23], s33 offen offset:1056 lds
    s_add_u32 s35, s36, 8448
    s_cselect_b32 s35, 0xffff5b00, s35
    s_add_u32 s33, s33, 131072
    v_add_u32 v5, s35, v3
    s_sub_u32 s41, s41, 1
L_fbret1I:
    s_cbranch_scc0 L_ret0I
L_ev0I:
    s_cmp_eq_u32 s42, 1
    s_cbranch_scc1 L_evB0I
    s_cmp_eq_u32 s42, 2
    s_cbranch_scc1 L_tail0I
    s_mov_b64 s[20:21], s[4:5]
    s_mov_b32 s22, s18
    s_mov_b32 s33, s17
    s_mov_b32 s41, 3
    s_mov_b32 s42, 1
    s_branch L_ret0I
L_evB0I:
    s_mov_b64 s[20:21], s[6:7]
    s_mov_b32 s22, s18
    s_mov_b32 s26, s18
    s_mov_b32 s33, s16
    s_mov_b32 s34, s16
    s_mov_b32 s41, 0
    s_mov_b32 s42, 2
    s_branch L_ret0I
L_ev1I:
    s_cmp_eq_u32 s42, 1
    s_cbranch_scc1 L_evB1I
    s_cmp_eq_u32 s42, 2
    s_cbranch_scc1 L_tail1I
    s_mov_b64 s[20:21], s[4:5]
    s_mov_b32 s22, s18
    s_mov_b32 s33, s17
    s_mov_b32 s41, 3
    s_mov_b32 s42, 1
    s_branch L_ret1I
L_evB1I:
    s_mov_b64 s[20:21], s[6:7]
    s_mov_b32 s22, s18
    s_mov_b32 s26, s18
    s_mov_b32 s33, s16
    s_mov_b32 s34, s16
    s_mov_b32 s41, 0
    s_mov_b32 s42, 2
    s_branch L_ret1I
L_evFI:
    s_cmp_eq_u32 s42, 1
    s_cbranch_scc1 L_evBFI
    s_mov_b64 s[20:21], s[4:5]
    s_mov_b32 s22, s18
    s_mov_b32 s33, s17
    s_mov_b32 s41, 3
    s_mov_b32 s42, 1
    s_branch L_retFxI
L_evBFI:
    s_mov_b64 s[20:21], s[6:7]
    s_mov_b32 s22, s18
    s_mov_b32 s26, s18
    s_mov_b32 s33, s16
    s_mov_b32 s34, s16
    s_mov_b32 s41, 0
    s_mov_b32 s42, 2
    s_branch L_retFxI
L_evSI:
    s_cmp_eq_u32 s42, 1
    s_cbranch_scc1 L_evBSI
    s_mov_b64 s[20:21], s[4:5]
    s_mov_b32 s22, s18
    s_mov_b32 s33, s17
    s_mov_b32 s41, 3
    s_mov_b32 s42, 1
    s_branch L_retSxI
L_evBSI:
    s_mov_b64 s[20:21], s[6:7]
    s_mov_b32 s22, s18
    s_mov_b32 s26, s18
    s_mov_b32 s33, s16
    s_mov_b32 s34, s16
    s_mov_b32 s41, 0
    s_mov_b32 s42, 2
    s_branch L_retSxI
L_tail0I:
    s_cmp_eq_u32 s19, 0
    s_cbranch_scc1 L_tailE0I
    s_add_u32 m0, s39, s38
    s_nop 0
    s_bfe_u32 s45, s15, 0x80008
    s_waitcnt vmcnt(10) lgkmcnt(0)
    s_barrier
    buffer_load_dwordx4 v1, s[24:27], s34 offen lds
    s_xor_b32 s38, s38, 0x4200
    s_sub_u32 s43, s36, 8448
    s_cmp_lt_u32 s43, 0xffff5b00
    s_cselect_b32 s43, 0xffffdf00, s43
    buffer_load_dwordx4 v2, s[24:27], s34 offen offset:1056 lds
    s_mov_b32 s44, s37
    s_add_u32 s34, s34, 131072
    v_add_u32 v6, s38, v4
    s_mov_b32 s37, s38
    s_cmp_eq_u32 s19, 0
L_fbretT0I:
L_trans0I:
    s_lshr_b32 s51, s19, 22
    s_add_u32 s51, s51, s32
    s_and_b32 s51, s51, 3
    s_lshl_b32 s45, s51, 17
    s_add_u32 s45, s45, s17
    s_cmp_ge_u32 s45, s18
    s_cbranch_scc0 L_trans0
    s_add_u32 s45, s51, 1
    s_mul_i32 s45, s45, 8448
    s_add_u32 s45, s45, s43
    s_cselect_b32 s46, 0xffff5b00, 0
    s_add_u32 s45, s45, s46
    v_add_u32 v5, s45, v3
    s_cmp_ge_u32 s32, 2
    s_cselect_b32 s45, s37, s44
    s_waitcnt vmcnt(6)
    s_barrier
    v_add_u32 v240, s45, v7
    v_add_u32 v244, s45, v8
    s_add_u32 s46, s3, s13
    s_mov_b32 s30, s14
    v_add_u32 v5, s43, v3
    s_add_u32 s47, s46, 32768
    s_add_u32 s48, s46, 65536
    s_add_u32 s53, s46, 98304
    s_lshl_b32 s3, s51, 17
    s_add_u32 s35, s43, 8448
    s_cselect_b32 s35, 0xffff5b00, s35
    s_add_u32 m0, s40, s35
    s_nop 0
    s_waitcnt vmcnt(2) lgkmcnt(0)
    s_barrier
    buffer_load_dwordx4 v1, s[20:23], s33 offen lds
    buffer_load_dwordx4 v2, s[20:23], s33 offen offset:1056 lds
    s_add_u32 s33, s33, 131072
    s_add_u32 s35, s35, 8448
    s_cselect_b32 s35, 0xffff5b00, s35
    s_add_u32 m0, s40, s35
    s_nop 0
    buffer_load_dwordx4 v1, s[20:23], s33 offen lds
    buffer_load_dwordx4 v2, s[20:23], s33 offen offset:1056 lds
    s_add_u32 s33, s33, 131072
    s_add_u32 s35, s35, 8448
    s_cselect_b32 s35, 0xffff5b00, s35
    s_add_u32 m0, s40, s35
    s_nop 0
    buffer_store_dwordx4 v[48:51], v9, s[28:31], s46 offen offset:0 nt
    buffer_store_dwordx4 v[52:55], v9, s[28:31], s47 offen offset:0 nt
    buffer_store_dwordx4 v[56:59], v9, s[28:31], s48 offen offset:0 nt
    buffer_store_dwordx4 v[60:63], v9, s[28:31], s53 offen offset:0 nt
    buffer_load_dwordx4 v1, s[20:23], s33 offen lds
    buffer_load_dwordx4 v2, s[20:23], s33 offen offset:1056 lds
    s_add_u32 s33, s33, 131072
    s_add_u32 s35, s35, 8448
    s_cselect_b32 s35, 0xffff5b00, s35
    s_add_u32 m0, s40, s35
    s_nop 0
    buffer_store_dwordx4 v[80:83], v9, s[28:31], s46 offen offset:128 nt
    buffer_store_dwordx4 v[84:87], v9, s[28:31], s47 offen offset:128 nt
    buffer_store_dwordx4 v[88:91], v9, s[28:31], s48 offen offset:128 nt
    buffer_store_dwordx4 v[92:95], v9, s[28:31], s53 offen offset:128 nt
    buffer_load_dwordx4 v1, s[20:23], s33 offen lds
    s_mov_b64 s[12:13], s[16:17]
    s_mov_b64 s[14:15], s[18:19]
    s_mov_b64 s[16:17], 0
    s_mov_b64 s[18:19], 0
    s_mov_b32 s62, 0
    buffer_load_dwordx4 v2, s[20:23], s33 offen offset:1056 lds
    s_add_u32 s33, s33, 131072
    s_waitcnt vmcnt(12)
    s_branch L_pre0
L_tailE0I:
    s_waitcnt vmcnt(6)
    s_barrier
    s_branch L_fin
L_tail1I:
    s_cmp_eq_u32 s19, 0
    s_cbranch_scc1 L_tailE1I
    s_add_u32 m0, s39, s37
    s_nop 0
    s_bfe_u32 s45, s15, 0x80008
    s_waitcnt vmcnt(10) lgkmcnt(0)
    s_barrier
    buffer_load_dwordx4 v1, s[24:27], s34 offen lds
    s_xor_b32 s37, s37, 0x4200
    s_sub_u32 s43, s35, 8448
    s_cmp_lt_u32 s43, 0xffff5b00
    s_cselect_b32 s43, 0xffffdf00, s43
    buffer_load_dwordx4 v2, s[24:27], s34 offen offset:1056 lds
    s_mov_b32 s44, s38
    s_add_u32 s34, s34, 131072
    v_add_u32 v6, s37, v4
    s_cmp_eq_u32 s19, 0
L_fbretT1I:
L_trans1I:
    s_lshr_b32 s51, s19, 22
    s_add_u32 s51, s51, s32
    s_and_b32 s51, s51, 3
    s_lshl_b32 s45, s51, 17
    s_add_u32 s45, s45, s17
    s_cmp_ge_u32 s45, s18
    s_cbranch_scc0 L_trans1
    s_add_u32 s45, s51, 1
    s_mul_i32 s45, s45, 8448
    s_add_u32 s45, s45, s43
    s_cselect_b32 s46, 0xffff5b00, 0
    s_add_u32 s45, s45, s46
    v_add_u32 v5, s45, v3
    s_cmp_ge_u32 s32, 2
    s_cselect_b32 s45, s37, s44
    s_waitcnt vmcnt(6)
    s_barrier
    v_add_u32 v240, s45, v7
    v_add_u32 v244, s45, v8
    s_add_u32 s46, s3, s13
    s_mov_b32 s30, s14
    v_add_u32 v5, s43, v3
    s_add_u32 s47, s46, 32768
    s_add_u32 s48, s46, 65536
    s_add_u32 s53, s46, 98304
    s_lshl_b32 s3, s51, 17
    s_add_u32 s35, s43, 8448
    s_cselect_b32 s35, 0xffff5b00, s35
    s_add_u32 m0, s40, s35
    s_nop 0
    s_waitcnt vmcnt(2) lgkmcnt(0)
    s_barrier
    buffer_load_dwordx4 v1, s[20:23], s33 offen lds
    buffer_load_dwordx4 v2, s[20:23], s33 offen offset:1056 lds
    s_add_u32 s33, s33, 131072
    s_add_u32 s35, s35, 8448
    s_cselect_b32 s35, 0xffff5b00, s35
    s_add_u32 m0, s40, s35
    s_nop 0
    buffer_load_dwordx4 v1, s[20:23], s33 offen lds
    buffer_load_dwordx4 v2, s[20:23], s33 offen offset:1056 lds
    s_add_u32 s33, s33, 131072
    s_add_u32 s35, s35, 8448
    s_cselect_b32 s35, 0xffff5b00, s35
    s_add_u32 m0, s40, s35
    s_nop 0
    buffer_store_dwordx4 v[48:51], v9, s[28:31], s46 offen offset:0 nt
    buffer_store_dwordx4 v[52:55], v9, s[28:31], s47 offen offset:0 nt
    buffer_store_dwordx4 v[56:59], v9, s[28:31], s48 offen offset:0 nt
    buffer_store_dwordx4 v[60:63], v9, s[28:31], s53 offen offset:0 nt
    buffer_load_dwordx4 v1, s[20:23], s33 offen lds
    buffer_load_dwordx4 v2, s[20:23], s33 offen offset:1056 lds
    s_add_u32 s33, s33, 131072
    s_add_u32 s35, s35, 8448
    s_cselect_b32 s35, 0xffff5b00, s35
    s_add_u32 m0, s40, s35
    s_nop 0
    buffer_store_dwordx4 v[80:83], v9, s[28:31], s46 offen offset:128 nt
    buffer_store_dwordx4 v[84:87], v9, s[28:31], s47 offen offset:128 nt
    buffer_store_dwordx4 v[88:91], v9, s[28:31], s48 offen offset:128 nt
    buffer_store_dwordx4 v[92:95], v9, s[28:31], s53 offen offset:128 nt
    buffer_load_dwordx4 v1, s[20:23], s33 offen lds
    s_mov_b64 s[12:13], s[16:17]
    s_mov_b64 s[14:15], s[18:19]
    s_mov_b64 s[16:17], 0
    s_mov_b64 s[18:19], 0
    s_mov_b32 s62, 0
    buffer_load_dwordx4 v2, s[20:23], s33 offen offset:1056 lds
    s_add_u32 s33, s33, 131072
    s_waitcnt vmcnt(12)
    s_branch L_pre0
L_tailE1I:
    s_waitcnt vmcnt(6)
    s_barrier
    s_branch L_fin
L_p1I:
    s_waitcnt vmcnt(6)
    v_add_u32 v5, s43, v3
    s_barrier
    s_add_u32 m0, s39, 59136
    s_nop 0
    buffer_load_dwordx4 v1, s[20:23], s33 offen lds
    buffer_load_dwordx4 v2, s[20:23], s33 offen offset:1056 lds
    s_add_u32 s33, s33, 131072
    s_add_u32 m0, s39, 67584
    s_nop 0
    buffer_load_dwordx4 v1, s[20:23], s33 offen lds
    buffer_load_dwordx4 v2, s[20:23], s33 offen offset:1056 lds
    s_add_u32 s33, s33, 131072
    s_waitcnt vmcnt(6)
    s_branch L_pre0
L_fbF:
    s_nop 7
    s_nop 1
    v_max3_f32 v11, v128, v129, v130
    v_max3_f32 v12, v136, v137, v138
    v_max3_f32 v11, v11, v131, v132
    v_max3_f32 v12, v12, v139, v140
    v_max3_f32 v11, v11, v133, v134
    v_max3_f32 v12, v12, v141, v142
    v_max_f32 v11, v11, v135
    v_max_f32 v12, v12, v143
    s_nop 1
    v_permlane32_swap_b32 v11, v12
    s_nop 1
    v_max_f32 v11, v11, v12
    v_mov_b32 v12, v11
    s_nop 1
    v_permlane16_swap_b32 v11, v12
    s_nop 1
    v_max_f32 v11, v11, v12
    v_mov_b32 v12, v11
    s_nop 1
    v_permlane32_swap_b32 v11, v12
    s_nop 1
    v_max_f32 v11, 0, v11
    v_max_f32 v12, 0, v12
    v_exp_f32 v14, -v11
    v_exp_f32 v15, -v12
    v_sub_f32 v128, v128, v11
    v_sub_f32 v129, v129, v11
    v_sub_f32 v130, v130, v11
    v_sub_f32 v131, v131, v11
    v_sub_f32 v132, v132, v11
    v_sub_f32 v133, v133, v11
    v_sub_f32 v134, v134, v11
    v_sub_f32 v135, v135, v11
    v_sub_f32 v136, v136, v12
    v_sub_f32 v137, v137, v12
    v_sub_f32 v138, v138, v12
    v_sub_f32 v139, v139, v12
    v_sub_f32 v140, v140, v12
    v_sub_f32 v141, v141, v12
    v_sub_f32 v142, v142, v12
    v_sub_f32 v143, v143, v12
    v_sub_f32 v112, v112, v11
    v_sub_f32 v113, v113, v11
    v_sub_f32 v114, v114, v11
    v_sub_f32 v115, v115, v11
    v_sub_f32 v116, v116, v11
    v_sub_f32 v117, v117, v11
    v_sub_f32 v118, v118, v11
    v_sub_f32 v119, v119, v11
    v_sub_f32 v120, v120, v12
    v_sub_f32 v121, v121, v12
    v_sub_f32 v122, v122, v12
    v_sub_f32 v123, v123, v12
    v_sub_f32 v124, v124, v12
    v_sub_f32 v125, v125, v12
    v_sub_f32 v126, v126, v12
    v_sub_f32 v127, v127, v12
    v_sub_f32 v224, v224, v11
    v_sub_f32 v225, v225, v11
    v_sub_f32 v226, v226, v11
    v_sub_f32 v227, v227, v11
    v_sub_f32 v228, v228, v12
    v_sub_f32 v229, v229, v12
    v_sub_f32 v230, v230, v12
    v_sub_f32 v231, v231, v12
    v_mul_f32 v232, v232, v14
    v_mul_f32 v233, v233, v15
    v_mul_f32 v48, v48, v14
    v_mul_f32 v49, v49, v14
    v_mul_f32 v50, v50, v14
    v_mul_f32 v51, v51, v14
    v_mul_f32 v52, v52, v15
    v_mul_f32 v53, v53, v15
    v_mul_f32 v54, v54, v15
    v_mul_f32 v55, v55, v15
    v_mul_f32 v56, v56, v14
    v_mul_f32 v57, v57, v14
    v_mul_f32 v58, v58, v14
    v_mul_f32 v59, v59, v14
    v_mul_f32 v60, v60, v15
    v_mul_f32 v61, v61, v15
    v_mul_f32 v62, v62, v15
    v_mul_f32 v63, v63, v15
    v_mul_f32 v64, v64, v14
    v_mul_f32 v65, v65, v14
    v_mul_f32 v66, v66, v14
    v_mul_f32 v67, v67, v14
    v_mul_f32 v68, v68, v15
    v_mul_f32 v69, v69, v15
    v_mul_f32 v70, v70, v15
    v_mul_f32 v71, v71, v15
    v_mul_f32 v72, v72, v14
    v_mul_f32 v73, v73, v14
    v_mul_f32 v74, v74, v14
    v_mul_f32 v75, v75, v14
    v_mul_f32 v76, v76, v15
    v_mul_f32 v77, v77, v15
    v_mul_f32 v78, v78, v15
    v_mul_f32 v79, v79, v15
    v_mul_f32 v80, v80, v14
    v_mul_f32 v81, v81, v14
    v_mul_f32 v82, v82, v14
    v_mul_f32 v83, v83, v14
    v_mul_f32 v84, v84, v15
    v_mul_f32 v85, v85, v15
    v_mul_f32 v86, v86, v15
    v_mul_f32 v87, v87, v15
    v_mul_f32 v88, v88, v14
    v_mul_f32 v89, v89, v14
    v_mul_f32 v90, v90, v14
    v_mul_f32 v91, v91, v14
    v_mul_f32 v92, v92, v15
    v_mul_f32 v93, v93, v15
    v_mul_f32 v94, v94, v15
    v_mul_f32 v95, v95, v15
    v_mul_f32 v96, v96, v14
    v_mul_f32 v97, v97, v14
    v_mul_f32 v98, v98, v14
    v_mul_f32 v99, v99, v14
    v_mul_f32 v100, v100, v15
    v_mul_f32 v101, v101, v15
    v_mul_f32 v102, v102, v15
    v_mul_f32 v103, v103, v15
    v_mul_f32 v104, v104, v14
    v_mul_f32 v105, v105, v14
    v_mul_f32 v106, v106, v14
    v_mul_f32 v107, v107, v14
    v_mul_f32 v108, v108, v15
    v_mul_f32 v109, v109, v15
    v_mul_f32 v110, v110, v15
    v_mul_f32 v111, v111, v15
    v_exp_f32 v236, v128
    s_nop 0
    v_exp_f32 v237, v129
    v_add_f32 v234, v232, v236
    s_nop 0
    v_exp_f32 v238, v130
    v_add_f32 v234, v234, v237
    v_cvt_pk_bf16_f32 v152, v236, v237
    s_nop 0
    v_exp_f32 v239, v131
    v_add_f32 v234, v234, v238
    s_nop 0
    v_exp_f32 v236, v132
    v_add_f32 v234, v234, v239
    v_cvt_pk_bf16_f32 v153, v238, v239
    s_nop 0
    v_exp_f32 v237, v133
    v_add_f32 v234, v234, v236
    s_nop 0
    v_exp_f32 v238, v134
    v_add_f32 v234, v234, v237
    v_cvt_pk_bf16_f32 v154, v236, v237
    s_nop 0
    v_exp_f32 v239, v135
    v_add_f32 v234, v234, v238
    s_nop 0
    v_exp_f32 v236, v136
    v_add_f32 v234, v234, v239
    v_cvt_pk_bf16_f32 v155, v238, v239
    s_nop 0
    v_exp_f32 v237, v137
    v_add_f32 v235, v233, v236
    s_nop 0
    v_exp_f32 v238, v138
    v_add_f32 v235, v235, v237
    v_cvt_pk_bf16_f32 v156, v236, v237
    s_nop 0
    v_exp_f32 v239, v139
    v_add_f32 v235, v235, v238
    s_nop 0
    v_exp_f32 v236, v140
    v_add_f32 v235, v235, v239
    v_cvt_pk_bf16_f32 v157, v238, v239
    s_nop 0
    v_exp_f32 v237, v141
    v_add_f32 v235, v235, v236
    s_nop 0
    v_exp_f32 v238, v142
    v_add_f32 v235, v235, v237
    v_cvt_pk_bf16_f32 v158, v236, v237
    s_nop 0
    v_exp_f32 v239, v143
    v_add_f32 v235, v235, v238
    s_nop 0
    v_add_f32 v235, v235, v239
    v_cvt_pk_bf16_f32 v159, v238, v239
    s_branch L_fbretF
L_fb0:
    s_nop 7
    s_nop 1
    v_max3_f32 v11, v112, v113, v114
    v_max3_f32 v12, v120, v121, v122
    v_max3_f32 v11, v11, v115, v116
    v_max3_f32 v12, v12, v123, v124
    v_max3_f32 v11, v11, v117, v118
    v_max3_f32 v12, v12, v125, v126
    v_max_f32 v11, v11, v119
    v_max_f32 v12, v12, v127
    s_nop 1
    v_permlane32_swap_b32 v11, v12
    s_nop 1
    v_max_f32 v11, v11, v12
    v_mov_b32 v12, v11
    s_nop 1
    v_permlane16_swap_b32 v11, v12
    s_nop 1
    v_max_f32 v11, v11, v12
    v_mov_b32 v12, v11
    s_nop 1
    v_permlane32_swap_b32 v11, v12
    s_nop 1
    v_max_f32 v11, 0, v11
    v_max_f32 v12, 0, v12
    v_exp_f32 v14, -v11
    v_exp_f32 v15, -v12
    v_sub_f32 v112, v112, v11
    v_sub_f32 v113, v113, v11
    v_sub_f32 v114, v114, v11
    v_sub_f32 v115, v115, v11
    v_sub_f32 v116, v116, v11
    v_sub_f32 v117, v117, v11
    v_sub_f32 v118, v118, v11
    v_sub_f32 v119, v119, v11
    v_sub_f32 v120, v120, v12
    v_sub_f32 v121, v121, v12
    v_sub_f32 v122, v122, v12
    v_sub_f32 v123, v123, v12
    v_sub_f32 v124, v124, v12
    v_sub_f32 v125, v125, v12
    v_sub_f32 v126, v126, v12
    v_sub_f32 v127, v127, v12
    v_sub_f32 v128, v128, v11
    v_sub_f32 v129, v129, v11
    v_sub_f32 v130, v130, v11
    v_sub_f32 v131, v131, v11
    v_sub_f32 v132, v132, v11
    v_sub_f32 v133, v133, v11
    v_sub_f32 v134, v134, v11
    v_sub_f32 v135, v135, v11
    v_sub_f32 v136, v136, v12
    v_sub_f32 v137, v137, v12
    v_sub_f32 v138, v138, v12
    v_sub_f32 v139, v139, v12
    v_sub_f32 v140, v140, v12
    v_sub_f32 v141, v141, v12
    v_sub_f32 v142, v142, v12
    v_sub_f32 v143, v143, v12
    v_sub_f32 v224, v224, v11
    v_sub_f32 v225, v225, v11
    v_sub_f32 v226, v226, v11
    v_sub_f32 v227, v227, v11
    v_sub_f32 v228, v228, v12
    v_sub_f32 v229, v229, v12
    v_sub_f32 v230, v230, v12
    v_sub_f32 v231, v231, v12
    v_mul_f32 v234, v234, v14
    v_mul_f32 v235, v235, v15
    v_mul_f32 v48, v48, v14
    v_mul_f32 v49, v49, v14
    v_mul_f32 v50, v50, v14
    v_mul_f32 v51, v51, v14
    v_mul_f32 v52, v52, v15
    v_mul_f32 v53, v53, v15
    v_mul_f32 v54, v54, v15
    v_mul_f32 v55, v55, v15
    v_mul_f32 v56, v56, v14
    v_mul_f32 v57, v57, v14
    v_mul_f32 v58, v58, v14
    v_mul_f32 v59, v59, v14
    v_mul_f32 v60, v60, v15
    v_mul_f32 v61, v61, v15
    v_mul_f32 v62, v62, v15
    v_mul_f32 v63, v63, v15
    v_mul_f32 v64, v64, v14
    v_mul_f32 v65, v65, v14
    v_mul_f32 v66, v66, v14
    v_mul_f32 v67, v67, v14
    v_mul_f32 v68, v68, v15
    v_mul_f32 v69, v69, v15
    v_mul_f32 v70, v70, v15
    v_mul_f32 v71, v71, v15
    v_mul_f32 v72, v72, v14
    v_mul_f32 v73, v73, v14
    v_mul_f32 v74, v74, v14
    v_mul_f32 v75, v75, v14
    v_mul_f32 v76, v76, v15
    v_mul_f32 v77, v77, v15
    v_mul_f32 v78, v78, v15
    v_mul_f32 v79, v79, v15
    v_mul_f32 v80, v80, v14
    v_mul_f32 v81, v81, v14
    v_mul_f32 v82, v82, v14
    v_mul_f32 v83, v83, v14
    v_mul_f32 v84, v84, v15
    v_mul_f32 v85, v85, v15
    v_mul_f32 v86, v86, v15
    v_mul_f32 v87, v87, v15
    v_mul_f32 v88, v88, v14
    v_mul_f32 v89, v89, v14
    v_mul_f32 v90, v90, v14
    v_mul_f32 v91, v91, v14
    v_mul_f32 v92, v92, v15
    v_mul_f32 v93, v93, v15
    v_mul_f32 v94, v94, v15
    v_mul_f32 v95, v95, v15
    v_mul_f32 v96, v96, v14
    v_mul_f32 v97, v97, v14
    v_mul_f32 v98, v98, v14
    v_mul_f32 v99, v99, v14
    v_mul_f32 v100, v100, v15
    v_mul_f32 v101, v101, v15
    v_mul_f32 v102, v102, v15
    v_mul_f32 v103, v103, v15
    v_mul_f32 v104, v104, v14
    v_mul_f32 v105, v105, v14
    v_mul_f32 v106, v106, v14
    v_mul_f32 v107, v107, v14
    v_mul_f32 v108, v108, v15
    v_mul_f32 v109, v109, v15
    v_mul_f32 v110, v110, v15
    v_mul_f32 v111, v111, v15
    v_exp_f32 v236, v112
    s_nop 0
    v_exp_f32 v237, v113
    v_add_f32 v232, v234, v236
    s_nop 0
    v_exp_f32 v238, v114
    v_add_f32 v232, v232, v237
    v_cvt_pk_bf16_f32 v144, v236, v237
    s_nop 0
    v_exp_f32 v239, v115
    v_add_f32 v232, v232, v238
    s_nop 0
    v_exp_f32 v236, v116
    v_add_f32 v232, v232, v239
    v_cvt_pk_bf16_f32 v145, v238, v239
    s_nop 0
    v_exp_f32 v237, v117
    v_add_f32 v232, v232, v236
    s_nop 0
    v_exp_f32 v238, v118
    v_add_f32 v232, v232, v237
    v_cvt_pk_bf16_f32 v146, v236, v237
    s_nop 0
    v_exp_f32 v239, v119
    v_add_f32 v232, v232, v238
    s_nop 0
    v_exp_f32 v236, v120
    v_add_f32 v232, v232, v239
    v_cvt_pk_bf16_f32 v147, v238, v239
    s_nop 0
    v_exp_f32 v237, v121
    v_add_f32 v233, v235, v236
    s_nop 0
    v_exp_f32 v238, v122
    v_add_f32 v233, v233, v237
    v_cvt_pk_bf16_f32 v148, v236, v237
    s_nop 0
    v_exp_f32 v239, v123
    v_add_f32 v233, v233, v238
    s_nop 0
    v_exp_f32 v236, v124
    v_add_f32 v233, v233, v239
    v_cvt_pk_bf16_f32 v149, v238, v239
    s_nop 0
    v_exp_f32 v237, v125
    v_add_f32 v233, v233, v236
    s_nop 0
    v_exp_f32 v238, v126
    v_add_f32 v233, v233, v237
    v_cvt_pk_bf16_f32 v150, v236, v237
    s_nop 0
    v_exp_f32 v239, v127
    v_add_f32 v233, v233, v238
    s_nop 0
    v_add_f32 v233, v233, v239
    v_cvt_pk_bf16_f32 v151, v238, v239
    s_branch L_fbret0
L_fb1:
    s_nop 7
    s_nop 1
    v_max3_f32 v11, v128, v129, v130
    v_max3_f32 v12, v136, v137, v138
    v_max3_f32 v11, v11, v131, v132
    v_max3_f32 v12, v12, v139, v140
    v_max3_f32 v11, v11, v133, v134
    v_max3_f32 v12, v12, v141, v142
    v_max_f32 v11, v11, v135
    v_max_f32 v12, v12, v143
    s_nop 1
    v_permlane32_swap_b32 v11, v12
    s_nop 1
    v_max_f32 v11, v11, v12
    v_mov_b32 v12, v11
    s_nop 1
    v_permlane16_swap_b32 v11, v12
    s_nop 1
    v_max_f32 v11, v11, v12
    v_mov_b32 v12, v11
    s_nop 1
    v_permlane32_swap_b32 v11, v12
    s_nop 1
    v_max_f32 v11, 0, v11
    v_max_f32 v12, 0, v12
    v_exp_f32 v14, -v11
    v_exp_f32 v15, -v12
    v_sub_f32 v128, v128, v11
    v_sub_f32 v129, v129, v11
    v_sub_f32 v130, v130, v11
    v_sub_f32 v131, v131, v11
    v_sub_f32 v132, v132, v11
    v_sub_f32 v133, v133, v11
    v_sub_f32 v134, v134, v11
    v_sub_f32 v135, v135, v11
    v_sub_f32 v136, v136, v12
    v_sub_f32 v137, v137, v12
    v_sub_f32 v138, v138, v12
    v_sub_f32 v139, v139, v12
    v_sub_f32 v140, v140, v12
    v_sub_f32 v141, v141, v12
    v_sub_f32 v142, v142, v12
    v_sub_f32 v143, v143, v12
    v_sub_f32 v112, v112, v11
    v_sub_f32 v113, v113, v11
    v_sub_f32 v114, v114, v11
    v_sub_f32 v115, v115, v11
    v_sub_f32 v116, v116, v11
    v_sub_f32 v117, v117, v11
    v_sub_f32 v118, v118, v11
    v_sub_f32 v119, v119, v11
    v_sub_f32 v120, v120, v12
    v_sub_f32 v121, v121, v12
    v_sub_f32 v122, v122, v12
    v_sub_f32 v123, v123, v12
    v_sub_f32 v124, v124, v12
    v_sub_f32 v125, v125, v12
    v_sub_f32 v126, v126, v12
    v_sub_f32 v127, v127, v12
    v_sub_f32 v224, v224, v11
    v_sub_f32 v225, v225, v11
    v_sub_f32 v226, v226, v11
    v_sub_f32 v227, v227, v11
    v_sub_f32 v228, v228, v12
    v_sub_f32 v229, v229, v12
    v_sub_f32 v230, v230, v12
    v_sub_f32 v231, v231, v12
    v_mul_f32 v232, v232, v14
    v_mul_f32 v233, v233, v15
    v_mul_f32 v48, v48, v14
    v_mul_f32 v49, v49, v14
    v_mul_f32 v50, v50, v14
    v_mul_f32 v51, v51, v14
    v_mul_f32 v52, v52, v15
    v_mul_f32 v53, v53, v15
    v_mul_f32 v54, v54, v15
    v_mul_f32 v55, v55, v15
    v_mul_f32 v56, v56, v14
    v_mul_f32 v57, v57, v14
    v_mul_f32 v58, v58, v14
    v_mul_f32 v59, v59, v14
    v_mul_f32 v60, v60, v15
    v_mul_f32 v61, v61, v15
    v_mul_f32 v62, v62, v15
    v_mul_f32 v63, v63, v15
    v_mul_f32 v64, v64, v14
    v_mul_f32 v65, v65, v14
    v_mul_f32 v66, v66, v14
    v_mul_f32 v67, v67, v14
    v_mul_f32 v68, v68, v15
    v_mul_f32 v69, v69, v15
    v_mul_f32 v70, v70, v15
    v_mul_f32 v71, v71, v15
    v_mul_f32 v72, v72, v14
    v_mul_f32 v73, v73, v14
    v_mul_f32 v74, v74, v14
    v_mul_f32 v75, v75, v14
    v_mul_f32 v76, v76, v15
    v_mul_f32 v77, v77, v15
    v_mul_f32 v78, v78, v15
    v_mul_f32 v79, v79, v15
    v_mul_f32 v80, v80, v14
    v_mul_f32 v81, v81, v14
    v_mul_f32 v82, v82, v14
    v_mul_f32 v83, v83, v14
    v_mul_f32 v84, v84, v15
    v_mul_f32 v85, v85, v15
    v_mul_f32 v86, v86, v15
    v_mul_f32 v87, v87, v15
    v_mul_f32 v88, v88, v14
    v_mul_f32 v89, v89, v14
    v_mul_f32 v90, v90, v14
    v_mul_f32 v91, v91, v14
    v_mul_f32 v92, v92, v15
    v_mul_f32 v93, v93, v15
    v_mul_f32 v94, v94, v15
    v_mul_f32 v95, v95, v15
    v_mul_f32 v96, v96, v14
    v_mul_f32 v97, v97, v14
    v_mul_f32 v98, v98, v14
    v_mul_f32 v99, v99, v14
    v_mul_f32 v100, v100, v15
    v_mul_f32 v101, v101, v15
    v_mul_f32 v102, v102, v15
    v_mul_f32 v103, v103, v15
    v_mul_f32 v104, v104, v14
    v_mul_f32 v105, v105, v14
    v_mul_f32 v106, v106, v14
    v_mul_f32 v107, v107, v14
    v_mul_f32 v108, v108, v15
    v_mul_f32 v109, v109, v15
    v_mul_f32 v110, v110, v15
    v_mul_f32 v111, v111, v15
    v_exp_f32 v236, v128
    s_nop 0
    v_exp_f32 v237, v129
    v_add_f32 v234, v232, v236
    s_nop 0
    v_exp_f32 v238, v130
    v_add_f32 v234, v234, v237
    v_cvt_pk_bf16_f32 v152, v236, v237
    s_nop 0
    v_exp_f32 v239, v131
    v_add_f32 v234, v234, v238
    s_nop 0
    v_exp_f32 v236, v132
    v_add_f32 v234, v234, v239
    v_cvt_pk_bf16_f32 v153, v238, v239
    s_nop 0
    v_exp_f32 v237, v133
    v_add_f32 v234, v234, v236
    s_nop 0
    v_exp_f32 v238, v134
    v_add_f32 v234, v234, v237
    v_cvt_pk_bf16_f32 v154, v236, v237
    s_nop 0
    v_exp_f32 v239, v135
    v_add_f32 v234, v234, v238
    s_nop 0
    v_exp_f32 v236, v136
    v_add_f32 v234, v234, v239
    v_cvt_pk_bf16_f32 v155, v238, v239
    s_nop 0
    v_exp_f32 v237, v137
    v_add_f32 v235, v233, v236
    s_nop 0
    v_exp_f32 v238, v138
    v_add_f32 v235, v235, v237
    v_cvt_pk_bf16_f32 v156, v236, v237
    s_nop 0
    v_exp_f32 v239, v139
    v_add_f32 v235, v235, v238
    s_nop 0
    v_exp_f32 v236, v140
    v_add_f32 v235, v235, v239
    v_cvt_pk_bf16_f32 v157, v238, v239
    s_nop 0
    v_exp_f32 v237, v141
    v_add_f32 v235, v235, v236
    s_nop 0
    v_exp_f32 v238, v142
    v_add_f32 v235, v235, v237
    v_cvt_pk_bf16_f32 v158, v236, v237
    s_nop 0
    v_exp_f32 v239, v143
    v_add_f32 v235, v235, v238
    s_nop 0
    v_add_f32 v235, v235, v239
    v_cvt_pk_bf16_f32 v159, v238, v239
    s_branch L_fbret1
L_fbR0:
    s_nop 7
    s_nop 1
    v_max3_f32 v11, v112, v113, v114
    v_max3_f32 v12, v120, v121, v122
    v_max3_f32 v11, v11, v115, v116
    v_max3_f32 v12, v12, v123, v124
    v_max3_f32 v11, v11, v117, v118
    v_max3_f32 v12, v12, v125, v126
    v_max_f32 v11, v11, v119
    v_max_f32 v12, v12, v127
    s_nop 1
    v_permlane32_swap_b32 v11, v12
    s_nop 1
    v_max_f32 v11, v11, v12
    v_mov_b32 v12, v11
    s_nop 1
    v_permlane16_swap_b32 v11, v12
    s_nop 1
    v_max_f32 v11, v11, v12
    v_mov_b32 v12, v11
    s_nop 1
    v_permlane32_swap_b32 v11, v12
    s_nop 1
    v_max_f32 v11, 0, v11
    v_max_f32 v12, 0, v12
    v_exp_f32 v14, -v11
    v_exp_f32 v15, -v12
    v_sub_f32 v112, v112, v11
    v_sub_f32 v113, v113, v11
    v_sub_f32 v114, v114, v11
    v_sub_f32 v115, v115, v11
    v_sub_f32 v116, v116, v11
    v_sub_f32 v117, v117, v11
    v_sub_f32 v118, v118, v11
    v_sub_f32 v119, v119, v11
    v_sub_f32 v120, v120, v12
    v_sub_f32 v121, v121, v12
    v_sub_f32 v122, v122, v12
    v_sub_f32 v123, v123, v12
    v_sub_f32 v124, v124, v12
    v_sub_f32 v125, v125, v12
    v_sub_f32 v126, v126, v12
    v_sub_f32 v127, v127, v12
    v_sub_f32 v128, v128, v11
    v_sub_f32 v129, v129, v11
    v_sub_f32 v130, v130, v11
    v_sub_f32 v131, v131, v11
    v_sub_f32 v132, v132, v11
    v_sub_f32 v133, v133, v11
    v_sub_f32 v134, v134, v11
    v_sub_f32 v135, v135, v11
    v_sub_f32 v136, v136, v12
    v_sub_f32 v137, v137, v12
    v_sub_f32 v138, v138, v12
    v_sub_f32 v139, v139, v12
    v_sub_f32 v140, v140, v12
    v_sub_f32 v141, v141, v12
    v_sub_f32 v142, v142, v12
    v_sub_f32 v143, v143, v12
    v_sub_f32 v224, v224, v11
    v_sub_f32 v225, v225, v11
    v_sub_f32 v226, v226, v11
    v_sub_f32 v227, v227, v11
    v_sub_f32 v228, v228, v12
    v_sub_f32 v229, v229, v12
    v_sub_f32 v230, v230, v12
    v_sub_f32 v231, v231, v12
    v_mul_f32 v234, v234, v14
    v_mul_f32 v235, v235, v15
    v_mul_f32 v48, v48, v14
    v_mul_f32 v49, v49, v14
    v_mul_f32 v50, v50, v14
    v_mul_f32 v51, v51, v14
    v_mul_f32 v52, v52, v15
    v_mul_f32 v53, v53, v15
    v_mul_f32 v54, v54, v15
    v_mul_f32 v55, v55, v15
    v_mul_f32 v56, v56, v14
    v_mul_f32 v57, v57, v14
    v_mul_f32 v58, v58, v14
    v_mul_f32 v59, v59, v14
    v_mul_f32 v60, v60, v15
    v_mul_f32 v61, v61, v15
    v_mul_f32 v62, v62, v15
    v_mul_f32 v63, v63, v15
    v_mul_f32 v64, v64, v14
    v_mul_f32 v65, v65, v14
    v_mul_f32 v66, v66, v14
    v_mul_f32 v67, v67, v14
    v_mul_f32 v68, v68, v15
    v_mul_f32 v69, v69, v15
    v_mul_f32 v70, v70, v15
    v_mul_f32 v71, v71, v15
    v_mul_f32 v72, v72, v14
    v_mul_f32 v73, v73, v14
    v_mul_f32 v74, v74, v14
    v_mul_f32 v75, v75, v14
    v_mul_f32 v76, v76, v15
    v_mul_f32 v77, v77, v15
    v_mul_f32 v78, v78, v15
    v_mul_f32 v79, v79, v15
    v_mul_f32 v80, v80, v14
    v_mul_f32 v81, v81, v14
    v_mul_f32 v82, v82, v14
    v_mul_f32 v83, v83, v14
    v_mul_f32 v84, v84, v15
    v_mul_f32 v85, v85, v15
    v_mul_f32 v86, v86, v15
    v_mul_f32 v87, v87, v15
    v_mul_f32 v88, v88, v14
    v_mul_f32 v89, v89, v14
    v_mul_f32 v90, v90, v14
    v_mul_f32 v91, v91, v14
    v_mul_f32 v92, v92, v15
    v_mul_f32 v93, v93, v15
    v_mul_f32 v94, v94, v15
    v_mul_f32 v95, v95, v15
    v_mul_f32 v96, v96, v14
    v_mul_f32 v97, v97, v14
    v_mul_f32 v98, v98, v14
    v_mul_f32 v99, v99, v14
    v_mul_f32 v100, v100, v15
    v_mul_f32 v101, v101, v15
    v_mul_f32 v102, v102, v15
    v_mul_f32 v103, v103, v15
    v_mul_f32 v104, v104, v14
    v_mul_f32 v105, v105, v14
    v_mul_f32 v106, v106, v14
    v_mul_f32 v107, v107, v14
    v_mul_f32 v108, v108, v15
    v_mul_f32 v109, v109, v15
    v_mul_f32 v110, v110, v15
    v_mul_f32 v111, v111, v15
    v_exp_f32 v236, v112
    s_nop 0
    v_exp_f32 v237, v113
    v_add_f32 v232, v234, v236
    s_nop 0
    v_exp_f32 v238, v114
    v_add_f32 v232, v232, v237
    v_cvt_pk_bf16_f32 v144, v236, v237
    s_nop 0
    v_exp_f32 v239, v115
    v_add_f32 v232, v232, v238
    s_nop 0
    v_exp_f32 v236, v116
    v_add_f32 v232, v232, v239
    v_cvt_pk_bf16_f32 v145, v238, v239
    s_nop 0
    v_exp_f32 v237, v117
    v_add_f32 v232, v232, v236
    s_nop 0
    v_exp_f32 v238, v118
    v_add_f32 v232, v232, v237
    v_cvt_pk_bf16_f32 v146, v236, v237
    s_nop 0
    v_exp_f32 v239, v119
    v_add_f32 v232, v232, v238
    s_nop 0
    v_exp_f32 v236, v120
    v_add_f32 v232, v232, v239
    v_cvt_pk_bf16_f32 v147, v238, v239
    s_nop 0
    v_exp_f32 v237, v121
    v_add_f32 v233, v235, v236
    s_nop 0
    v_exp_f32 v238, v122
    v_add_f32 v233, v233, v237
    v_cvt_pk_bf16_f32 v148, v236, v237
    s_nop 0
    v_exp_f32 v239, v123
    v_add_f32 v233, v233, v238
    s_nop 0
    v_exp_f32 v236, v124
    v_add_f32 v233, v233, v239
    v_cvt_pk_bf16_f32 v149, v238, v239
    s_nop 0
    v_exp_f32 v237, v125
    v_add_f32 v233, v233, v236
    s_nop 0
    v_exp_f32 v238, v126
    v_add_f32 v233, v233, v237
    v_cvt_pk_bf16_f32 v150, v236, v237
    s_nop 0
    v_exp_f32 v239, v127
    v_add_f32 v233, v233, v238
    s_nop 0
    v_add_f32 v233, v233, v239
    v_cvt_pk_bf16_f32 v151, v238, v239
    s_branch L_fbretR0
L_fbR1:
    s_nop 7
    s_nop 1
    v_max3_f32 v11, v128, v129, v130
    v_max3_f32 v12, v136, v137, v138
    v_max3_f32 v11, v11, v131, v132
    v_max3_f32 v12, v12, v139, v140
    v_max3_f32 v11, v11, v133, v134
    v_max3_f32 v12, v12, v141, v142
    v_max_f32 v11, v11, v135
    v_max_f32 v12, v12, v143
    s_nop 1
    v_permlane32_swap_b32 v11, v12
    s_nop 1
    v_max_f32 v11, v11, v12
    v_mov_b32 v12, v11
    s_nop 1
    v_permlane16_swap_b32 v11, v12
    s_nop 1
    v_max_f32 v11, v11, v12
    v_mov_b32 v12, v11
    s_nop 1
    v_permlane32_swap_b32 v11, v12
    s_nop 1
    v_max_f32 v11, 0, v11
    v_max_f32 v12, 0, v12
    v_exp_f32 v14, -v11
    v_exp_f32 v15, -v12
    v_sub_f32 v128, v128, v11
    v_sub_f32 v129, v129, v11
    v_sub_f32 v130, v130, v11
    v_sub_f32 v131, v131, v11
    v_sub_f32 v132, v132, v11
    v_sub_f32 v133, v133, v11
    v_sub_f32 v134, v134, v11
    v_sub_f32 v135, v135, v11
    v_sub_f32 v136, v136, v12
    v_sub_f32 v137, v137, v12
    v_sub_f32 v138, v138, v12
    v_sub_f32 v139, v139, v12
    v_sub_f32 v140, v140, v12
    v_sub_f32 v141, v141, v12
    v_sub_f32 v142, v142, v12
    v_sub_f32 v143, v143, v12
    v_sub_f32 v112, v112, v11
    v_sub_f32 v113, v113, v11
    v_sub_f32 v114, v114, v11
    v_sub_f32 v115, v115, v11
    v_sub_f32 v116, v116, v11
    v_sub_f32 v117, v117, v11
    v_sub_f32 v118, v118, v11
    v_sub_f32 v119, v119, v11
    v_sub_f32 v120, v120, v12
    v_sub_f32 v121, v121, v12
    v_sub_f32 v122, v122, v12
    v_sub_f32 v123, v123, v12
    v_sub_f32 v124, v124, v12
    v_sub_f32 v125, v125, v12
    v_sub_f32 v126, v126, v12
    v_sub_f32 v127, v127, v12
    v_sub_f32 v224, v224, v11
    v_sub_f32 v225, v225, v11
    v_sub_f32 v226, v226, v11
    v_sub_f32 v227, v227, v11
    v_sub_f32 v228, v228, v12
    v_sub_f32 v229, v229, v12
    v_sub_f32 v230, v230, v12
    v_sub_f32 v231, v231, v12
    v_mul_f32 v232, v232, v14
    v_mul_f32 v233, v233, v15
    v_mul_f32 v48, v48, v14
    v_mul_f32 v49, v49, v14
    v_mul_f32 v50, v50, v14
    v_mul_f32 v51, v51, v14
    v_mul_f32 v52, v52, v15
    v_mul_f32 v53, v53, v15
    v_mul_f32 v54, v54, v15
    v_mul_f32 v55, v55, v15
    v_mul_f32 v56, v56, v14
    v_mul_f32 v57, v57, v14
    v_mul_f32 v58, v58, v14
    v_mul_f32 v59, v59, v14
    v_mul_f32 v60, v60, v15
    v_mul_f32 v61, v61, v15
    v_mul_f32 v62, v62, v15
    v_mul_f32 v63, v63, v15
    v_mul_f32 v64, v64, v14
    v_mul_f32 v65, v65, v14
    v_mul_f32 v66, v66, v14
    v_mul_f32 v67, v67, v14
    v_mul_f32 v68, v68, v15
    v_mul_f32 v69, v69, v15
    v_mul_f32 v70, v70, v15
    v_mul_f32 v71, v71, v15
    v_mul_f32 v72, v72, v14
    v_mul_f32 v73, v73, v14
    v_mul_f32 v74, v74, v14
    v_mul_f32 v75, v75, v14
    v_mul_f32 v76, v76, v15
    v_mul_f32 v77, v77, v15
    v_mul_f32 v78, v78, v15
    v_mul_f32 v79, v79, v15
    v_mul_f32 v80, v80, v14
    v_mul_f32 v81, v81, v14
    v_mul_f32 v82, v82, v14
    v_mul_f32 v83, v83, v14
    v_mul_f32 v84, v84, v15
    v_mul_f32 v85, v85, v15
    v_mul_f32 v86, v86, v15
    v_mul_f32 v87, v87, v15
    v_mul_f32 v88, v88, v14
    v_mul_f32 v89, v89, v14
    v_mul_f32 v90, v90, v14
    v_mul_f32 v91, v91, v14
    v_mul_f32 v92, v92, v15
    v_mul_f32 v93, v93, v15
    v_mul_f32 v94, v94, v15
    v_mul_f32 v95, v95, v15
    v_mul_f32 v96, v96, v14
    v_mul_f32 v97, v97, v14
    v_mul_f32 v98, v98, v14
    v_mul_f32 v99, v99, v14
    v_mul_f32 v100, v100, v15
    v_mul_f32 v101, v101, v15
    v_mul_f32 v102, v102, v15
    v_mul_f32 v103, v103, v15
    v_mul_f32 v104, v104, v14
    v_mul_f32 v105, v105, v14
    v_mul_f32 v106, v106, v14
    v_mul_f32 v107, v107, v14
    v_mul_f32 v108, v108, v15
    v_mul_f32 v109, v109, v15
    v_mul_f32 v110, v110, v15
    v_mul_f32 v111, v111, v15
    v_exp_f32 v236, v128
    s_nop 0
    v_exp_f32 v237, v129
    v_add_f32 v234, v232, v236
    s_nop 0
    v_exp_f32 v238, v130
    v_add_f32 v234, v234, v237
    v_cvt_pk_bf16_f32 v152, v236, v237
    s_nop 0
    v_exp_f32 v239, v131
    v_add_f32 v234, v234, v238
    s_nop 0
    v_exp_f32 v236, v132
    v_add_f32 v234, v234, v239
    v_cvt_pk_bf16_f32 v153, v238, v239
    s_nop 0
    v_exp_f32 v237, v133
    v_add_f32 v234, v234, v236
    s_nop 0
    v_exp_f32 v238, v134
    v_add_f32 v234, v234, v237
    v_cvt_pk_bf16_f32 v154, v236, v237
    s_nop 0
    v_exp_f32 v239, v135
    v_add_f32 v234, v234, v238
    s_nop 0
    v_exp_f32 v236, v136
    v_add_f32 v234, v234, v239
    v_cvt_pk_bf16_f32 v155, v238, v239
    s_nop 0
    v_exp_f32 v237, v137
    v_add_f32 v235, v233, v236
    s_nop 0
    v_exp_f32 v238, v138
    v_add_f32 v235, v235, v237
    v_cvt_pk_bf16_f32 v156, v236, v237
    s_nop 0
    v_exp_f32 v239, v139
    v_add_f32 v235, v235, v238
    s_nop 0
    v_exp_f32 v236, v140
    v_add_f32 v235, v235, v239
    v_cvt_pk_bf16_f32 v157, v238, v239
    s_nop 0
    v_exp_f32 v237, v141
    v_add_f32 v235, v235, v236
    s_nop 0
    v_exp_f32 v238, v142
    v_add_f32 v235, v235, v237
    v_cvt_pk_bf16_f32 v158, v236, v237
    s_nop 0
    v_exp_f32 v239, v143
    v_add_f32 v235, v235, v238
    s_nop 0
    v_add_f32 v235, v235, v239
    v_cvt_pk_bf16_f32 v159, v238, v239
    s_branch L_fbretR1
L_fbTR0:
    v_mov_b32 v116, 0xff800000
    v_mov_b32 v117, 0xff800000
    v_mov_b32 v118, 0xff800000
    v_mov_b32 v119, 0xff800000
    v_mov_b32 v124, 0xff800000
    v_mov_b32 v125, 0xff800000
    v_mov_b32 v126, 0xff800000
    v_mov_b32 v127, 0xff800000
L_fbT0:
    s_nop 7
    s_nop 1
    v_max3_f32 v11, v112, v113, v114
    v_max3_f32 v12, v120, v121, v122
    v_max3_f32 v11, v11, v115, v116
    v_max3_f32 v12, v12, v123, v124
    v_max3_f32 v11, v11, v117, v118
    v_max3_f32 v12, v12, v125, v126
    v_max_f32 v11, v11, v119
    v_max_f32 v12, v12, v127
    s_nop 1
    v_permlane32_swap_b32 v11, v12
    s_nop 1
    v_max_f32 v11, v11, v12
    v_mov_b32 v12, v11
    s_nop 1
    v_permlane16_swap_b32 v11, v12
    s_nop 1
    v_max_f32 v11, v11, v12
    v_mov_b32 v12, v11
    s_nop 1
    v_permlane32_swap_b32 v11, v12
    s_nop 1
    v_max_f32 v11, 0, v11
    v_max_f32 v12, 0, v12
    v_exp_f32 v14, -v11
    v_exp_f32 v15, -v12
    v_sub_f32 v112, v112, v11
    v_sub_f32 v113, v113, v11
    v_sub_f32 v114, v114, v11
    v_sub_f32 v115, v115, v11
    v_sub_f32 v116, v116, v11
    v_sub_f32 v117, v117, v11
    v_sub_f32 v118, v118, v11
    v_sub_f32 v119, v119, v11
    v_sub_f32 v120, v120, v12
    v_sub_f32 v121, v121, v12
    v_sub_f32 v122, v122, v12
    v_sub_f32 v123, v123, v12
    v_sub_f32 v124, v124, v12
    v_sub_f32 v125, v125, v12
    v_sub_f32 v126, v126, v12
    v_sub_f32 v127, v127, v12
    v_mul_f32 v234, v234, v14
    v_mul_f32 v235, v235, v15
    v_mul_f32 v48, v48, v14
    v_mul_f32 v49, v49, v14
    v_mul_f32 v50, v50, v14
    v_mul_f32 v51, v51, v14
    v_mul_f32 v52, v52, v15
    v_mul_f32 v53, v53, v15
    v_mul_f32 v54, v54, v15
    v_mul_f32 v55, v55, v15
    v_mul_f32 v56, v56, v14
    v_mul_f32 v57, v57, v14
    v_mul_f32 v58, v58, v14
    v_mul_f32 v59, v59, v14
    v_mul_f32 v60, v60, v15
    v_mul_f32 v61, v61, v15
    v_mul_f32 v62, v62, v15
    v_mul_f32 v63, v63, v15
    v_mul_f32 v64, v64, v14
    v_mul_f32 v65, v65, v14
    v_mul_f32 v66, v66, v14
    v_mul_f32 v67, v67, v14
    v_mul_f32 v68, v68, v15
    v_mul_f32 v69, v69, v15
    v_mul_f32 v70, v70, v15
    v_mul_f32 v71, v71, v15
    v_mul_f32 v72, v72, v14
    v_mul_f32 v73, v73, v14
    v_mul_f32 v74, v74, v14
    v_mul_f32 v75, v75, v14
    v_mul_f32 v76, v76, v15
    v_mul_f32 v77, v77, v15
    v_mul_f32 v78, v78, v15
    v_mul_f32 v79, v79, v15
    v_mul_f32 v80, v80, v14
    v_mul_f32 v81, v81, v14
    v_mul_f32 v82, v82, v14
    v_mul_f32 v83, v83, v14
    v_mul_f32 v84, v84, v15
    v_mul_f32 v85, v85, v15
    v_mul_f32 v86, v86, v15
    v_mul_f32 v87, v87, v15
    v_mul_f32 v88, v88, v14
    v_mul_f32 v89, v89, v14
    v_mul_f32 v90, v90, v14
    v_mul_f32 v91, v91, v14
    v_mul_f32 v92, v92, v15
    v_mul_f32 v93, v93, v15
    v_mul_f32 v94, v94, v15
    v_mul_f32 v95, v95, v15
    v_mul_f32 v96, v96, v14
    v_mul_f32 v97, v97, v14
    v_mul_f32 v98, v98, v14
    v_mul_f32 v99, v99, v14
    v_mul_f32 v100, v100, v15
    v_mul_f32 v101, v101, v15
    v_mul_f32 v102, v102, v15
    v_mul_f32 v103, v103, v15
    v_mul_f32 v104, v104, v14
    v_mul_f32 v105, v105, v14
    v_mul_f32 v106, v106, v14
    v_mul_f32 v107, v107, v14
    v_mul_f32 v108, v108, v15
    v_mul_f32 v109, v109, v15
    v_mul_f32 v110, v110, v15
    v_mul_f32 v111, v111, v15
    v_exp_f32 v236, v112
    s_nop 0
    v_exp_f32 v237, v113
    v_add_f32 v232, v234, v236
    s_nop 0
    v_exp_f32 v238, v114
    v_add_f32 v232, v232, v237
    v_cvt_pk_bf16_f32 v144, v236, v237
    s_nop 0
    v_exp_f32 v239, v115
    v_add_f32 v232, v232, v238
    s_nop 0
    v_exp_f32 v236, v116
    v_add_f32 v232, v232, v239
    v_cvt_pk_bf16_f32 v145, v238, v239
    s_nop 0
    v_exp_f32 v237, v117
    v_add_f32 v232, v232, v236
    s_nop 0
    v_exp_f32 v238, v118
    v_add_f32 v232, v232, v237
    v_cvt_pk_bf16_f32 v146, v236, v237
    s_nop 0
    v_exp_f32 v239, v119
    v_add_f32 v232, v232, v238
    s_nop 0
    v_exp_f32 v236, v120
    v_add_f32 v232, v232, v239
    v_cvt_pk_bf16_f32 v147, v238, v239
    s_nop 0
    v_exp_f32 v237, v121
    v_add_f32 v233, v235, v236
    s_nop 0
    v_exp_f32 v238, v122
    v_add_f32 v233, v233, v237
    v_cvt_pk_bf16_f32 v148, v236, v237
    s_nop 0
    v_exp_f32 v239, v123
    v_add_f32 v233, v233, v238
    s_nop 0
    v_exp_f32 v236, v124
    v_add_f32 v233, v233, v239
    v_cvt_pk_bf16_f32 v149, v238, v239
    s_nop 0
    v_exp_f32 v237, v125
    v_add_f32 v233, v233, v236
    s_nop 0
    v_exp_f32 v238, v126
    v_add_f32 v233, v233, v237
    v_cvt_pk_bf16_f32 v150, v236, v237
    s_nop 0
    v_exp_f32 v239, v127
    v_add_f32 v233, v233, v238
    s_nop 0
    v_add_f32 v233, v233, v239
    v_cvt_pk_bf16_f32 v151, v238, v239
    s_cbranch_scc1 L_fbretE0
    s_branch L_fbretT0
L_fbTR1:
    v_mov_b32 v132, 0xff800000
    v_mov_b32 v133, 0xff800000
    v_mov_b32 v134, 0xff800000
    v_mov_b32 v135, 0xff800000
    v_mov_b32 v140, 0xff800000
    v_mov_b32 v141, 0xff800000
    v_mov_b32 v142, 0xff800000
    v_mov_b32 v143, 0xff800000
L_fbT1:
    s_nop 7
    s_nop 1
    v_max3_f32 v11, v128, v129, v130
    v_max3_f32 v12, v136, v137, v138
    v_max3_f32 v11, v11, v131, v132
    v_max3_f32 v12, v12, v139, v140
    v_max3_f32 v11, v11, v133, v134
    v_max3_f32 v12, v12, v141, v142
    v_max_f32 v11, v11, v135
    v_max_f32 v12, v12, v143
    s_nop 1
    v_permlane32_swap_b32 v11, v12
    s_nop 1
    v_max_f32 v11, v11, v12
    v_mov_b32 v12, v11
    s_nop 1
    v_permlane16_swap_b32 v11, v12
    s_nop 1
    v_max_f32 v11, v11, v12
    v_mov_b32 v12, v11
    s_nop 1
    v_permlane32_swap_b32 v11, v12
    s_nop 1
    v_max_f32 v11, 0, v11
    v_max_f32 v12, 0, v12
    v_exp_f32 v14, -v11
    v_exp_f32 v15, -v12
    v_sub_f32 v128, v128, v11
    v_sub_f32 v129, v129, v11
    v_sub_f32 v130, v130, v11
    v_sub_f32 v131, v131, v11
    v_sub_f32 v132, v132, v11
    v_sub_f32 v133, v133, v11
    v_sub_f32 v134, v134, v11
    v_sub_f32 v135, v135, v11
    v_sub_f32 v136, v136, v12
    v_sub_f32 v137, v137, v12
    v_sub_f32 v138, v138, v12
    v_sub_f32 v139, v139, v12
    v_sub_f32 v140, v140, v12
    v_sub_f32 v141, v141, v12
    v_sub_f32 v142, v142, v12
    v_sub_f32 v143, v143, v12
    v_mul_f32 v232, v232, v14
    v_mul_f32 v233, v233, v15
    v_mul_f32 v48, v48, v14
    v_mul_f32 v49, v49, v14
    v_mul_f32 v50, v50, v14
    v_mul_f32 v51, v51, v14
    v_mul_f32 v52, v52, v15
    v_mul_f32 v53, v53, v15
    v_mul_f32 v54, v54, v15
    v_mul_f32 v55, v55, v15
    v_mul_f32 v56, v56, v14
    v_mul_f32 v57, v57, v14
    v_mul_f32 v58, v58, v14
    v_mul_f32 v59, v59, v14
    v_mul_f32 v60, v60, v15
    v_mul_f32 v61, v61, v15
    v_mul_f32 v62, v62, v15
    v_mul_f32 v63, v63, v15
    v_mul_f32 v64, v64, v14
    v_mul_f32 v65, v65, v14
    v_mul_f32 v66, v66, v14
    v_mul_f32 v67, v67, v14
    v_mul_f32 v68, v68, v15
    v_mul_f32 v69, v69, v15
    v_mul_f32 v70, v70, v15
    v_mul_f32 v71, v71, v15
    v_mul_f32 v72, v72, v14
    v_mul_f32 v73, v73, v14
    v_mul_f32 v74, v74, v14
    v_mul_f32 v75, v75, v14
    v_mul_f32 v76, v76, v15
    v_mul_f32 v77, v77, v15
    v_mul_f32 v78, v78, v15
    v_mul_f32 v79, v79, v15
    v_mul_f32 v80, v80, v14
    v_mul_f32 v81, v81, v14
    v_mul_f32 v82, v82, v14
    v_mul_f32 v83, v83, v14
    v_mul_f32 v84, v84, v15
    v_mul_f32 v85, v85, v15
    v_mul_f32 v86, v86, v15
    v_mul_f32 v87, v87, v15
    v_mul_f32 v88, v88, v14
    v_mul_f32 v89, v89, v14
    v_mul_f32 v90, v90, v14
    v_mul_f32 v91, v91, v14
    v_mul_f32 v92, v92, v15
    v_mul_f32 v93, v93, v15
    v_mul_f32 v94, v94, v15
    v_mul_f32 v95, v95, v15
    v_mul_f32 v96, v96, v14
    v_mul_f32 v97, v97, v14
    v_mul_f32 v98, v98, v14
    v_mul_f32 v99, v99, v14
    v_mul_f32 v100, v100, v15
    v_mul_f32 v101, v101, v15
    v_mul_f32 v102, v102, v15
    v_mul_f32 v103, v103, v15
    v_mul_f32 v104, v104, v14
    v_mul_f32 v105, v105, v14
    v_mul_f32 v106, v106, v14
    v_mul_f32 v107, v107, v14
    v_mul_f32 v108, v108, v15
    v_mul_f32 v109, v109, v15
    v_mul_f32 v110, v110, v15
    v_mul_f32 v111, v111, v15
    v_exp_f32 v236, v128
    s_nop 0
    v_exp_f32 v237, v129
    v_add_f32 v234, v232, v236
    s_nop 0
    v_exp_f32 v238, v130
    v_add_f32 v234, v234, v237
    v_cvt_pk_bf16_f32 v152, v236, v237
    s_nop 0
    v_exp_f32 v239, v131
    v_add_f32 v234, v234, v238
    s_nop 0
    v_exp_f32 v236, v132
    v_add_f32 v234, v234, v239
    v_cvt_pk_bf16_f32 v153, v238, v239
    s_nop 0
    v_exp_f32 v237, v133
    v_add_f32 v234, v234, v236
    s_nop 0
    v_exp_f32 v238, v134
    v_add_f32 v234, v234, v237
    v_cvt_pk_bf16_f32 v154, v236, v237
    s_nop 0
    v_exp_f32 v239, v135
    v_add_f32 v234, v234, v238
    s_nop 0
    v_exp_f32 v236, v136
    v_add_f32 v234, v234, v239
    v_cvt_pk_bf16_f32 v155, v238, v239
    s_nop 0
    v_exp_f32 v237, v137
    v_add_f32 v235, v233, v236
    s_nop 0
    v_exp_f32 v238, v138
    v_add_f32 v235, v235, v237
    v_cvt_pk_bf16_f32 v156, v236, v237
    s_nop 0
    v_exp_f32 v239, v139
    v_add_f32 v235, v235, v238
    s_nop 0
    v_exp_f32 v236, v140
    v_add_f32 v235, v235, v239
    v_cvt_pk_bf16_f32 v157, v238, v239
    s_nop 0
    v_exp_f32 v237, v141
    v_add_f32 v235, v235, v236
    s_nop 0
    v_exp_f32 v238, v142
    v_add_f32 v235, v235, v237
    v_cvt_pk_bf16_f32 v158, v236, v237
    s_nop 0
    v_exp_f32 v239, v143
    v_add_f32 v235, v235, v238
    s_nop 0
    v_add_f32 v235, v235, v239
    v_cvt_pk_bf16_f32 v159, v238, v239
    s_cbranch_scc1 L_fbretE1
    s_branch L_fbretT1
L_fbS:
    s_nop 7
    s_nop 1
    v_max3_f32 v11, v112, v113, v114
    v_max3_f32 v12, v120, v121, v122
    v_max3_f32 v11, v11, v115, v116
    v_max3_f32 v12, v12, v123, v124
    v_max3_f32 v11, v11, v117, v118
    v_max3_f32 v12, v12, v125, v126
    v_max_f32 v11, v11, v119
    v_max_f32 v12, v12, v127
    s_nop 1
    v_permlane32_swap_b32 v11, v12
    s_nop 1
    v_max_f32 v11, v11, v12
    v_mov_b32 v12, v11
    s_nop 1
    v_permlane16_swap_b32 v11, v12
    s_nop 1
    v_max_f32 v11, v11, v12
    v_mov_b32 v12, v11
    s_nop 1
    v_permlane32_swap_b32 v11, v12
    s_nop 1
    v_sub_f32 v112, v112, v11
    v_sub_f32 v113, v113, v11
    v_sub_f32 v114, v114, v11
    v_sub_f32 v115, v115, v11
    v_sub_f32 v116, v116, v11
    v_sub_f32 v117, v117, v11
    v_sub_f32 v118, v118, v11
    v_sub_f32 v119, v119, v11
    v_sub_f32 v120, v120, v12
    v_sub_f32 v121, v121, v12
    v_sub_f32 v122, v122, v12
    v_sub_f32 v123, v123, v12
    v_sub_f32 v124, v124, v12
    v_sub_f32 v125, v125, v12
    v_sub_f32 v126, v126, v12
    v_sub_f32 v127, v127, v12
    v_sub_f32 v128, v128, v11
    v_sub_f32 v129, v129, v11
    v_sub_f32 v130, v130, v11
    v_sub_f32 v131, v131, v11
    v_sub_f32 v132, v132, v11
    v_sub_f32 v133, v133, v11
    v_sub_f32 v134, v134, v11
    v_sub_f32 v135, v135, v11
    v_sub_f32 v136, v136, v12
    v_sub_f32 v137, v137, v12
    v_sub_f32 v138, v138, v12
    v_sub_f32 v139, v139, v12
    v_sub_f32 v140, v140, v12
    v_sub_f32 v141, v141, v12
    v_sub_f32 v142, v142, v12
    v_sub_f32 v143, v143, v12
    v_sub_f32 v224, v224, v11
    v_sub_f32 v225, v225, v11
    v_sub_f32 v226, v226, v11
    v_sub_f32 v227, v227, v11
    v_sub_f32 v228, v228, v12
    v_sub_f32 v229, v229, v12
    v_sub_f32 v230, v230, v12
    v_sub_f32 v231, v231, v12
    v_exp_f32 v236, v112
    s_nop 0
    v_exp_f32 v237, v113
    v_mov_b32 v232, v236
    s_nop 0
    v_exp_f32 v238, v114
    v_add_f32 v232, v232, v237
    v_cvt_pk_bf16_f32 v144, v236, v237
    s_nop 0
    v_exp_f32 v239, v115
    v_add_f32 v232, v232, v238
    s_nop 0
    v_exp_f32 v236, v116
    v_add_f32 v232, v232, v239
    v_cvt_pk_bf16_f32 v145, v238, v239
    s_nop 0
    v_exp_f32 v237, v117
    v_add_f32 v232, v232, v236
    s_nop 0
    v_exp_f32 v238, v118
    v_add_f32 v232, v232, v237
    v_cvt_pk_bf16_f32 v146, v236, v237
    s_nop 0
    v_exp_f32 v239, v119
    v_add_f32 v232, v232, v238
    s_nop 0
    v_exp_f32 v236, v120
    v_add_f32 v232, v232, v239
    v_cvt_pk_bf16_f32 v147, v238, v239
    s_nop 0
    v_exp_f32 v237, v121
    v_mov_b32 v233, v236
    s_nop 0
    v_exp_f32 v238, v122
    v_add_f32 v233, v233, v237
    v_cvt_pk_bf16_f32 v148, v236, v237
    s_nop 0
    v_exp_f32 v239, v123
    v_add_f32 v233, v233, v238
    s_nop 0
    v_exp_f32 v236, v124
    v_add_f32 v233, v233, v239
    v_cvt_pk_bf16_f32 v149, v238, v239
    s_nop 0
    v_exp_f32 v237, v125
    v_add_f32 v233, v233, v236
    s_nop 0
    v_exp_f32 v238, v126
    v_add_f32 v233, v233, v237
    v_cvt_pk_bf16_f32 v150, v236, v237
    s_nop 0
    v_exp_f32 v239, v127
    v_add_f32 v233, v233, v238
    s_nop 0
    v_add_f32 v233, v233, v239
    v_cvt_pk_bf16_f32 v151, v238, v239
    s_branch L_fbretS
L_fin:
L_end:
    s_endpgm
.p2align 6
.type L_table,@object
L_table:
    .long 0x0036ed00, 0x0036ed00, 0x00513000, 0x0000050e, 0x00000000, 0x00000000, 0x00000000, 0x00000000
    .long 0x0036ee00, 0x0036ee00, 0x00513000, 0x0000050e, 0x00000000, 0x00000000, 0x00000000, 0x00000000
    .long 0x0036e100, 0x0036e100, 0x00513000, 0x0000050e, 0x00000000, 0x00000000, 0x00000000, 0x00000000
    .long 0x0036e200, 0x0036e200, 0x00513000, 0x0000050e, 0x00000000, 0x00000000, 0x00000000, 0x00000000
    .long 0x0036e500, 0x0036e500, 0x00513000, 0x0000050e, 0x00000000, 0x00000000, 0x00000000, 0x00000000
    .long 0x0036e600, 0x0036e600, 0x00513000, 0x0000050e, 0x00000000, 0x00000000, 0x00000000, 0x00000000
    .long 0x0036e900, 0x0036e900, 0x00513000, 0x0000050e, 0x00000000, 0x00000000, 0x00000000, 0x00000000
    .long 0x0036ea00, 0x0036ea00, 0x00513000, 0x0000050e, 0x00000000, 0x00000000, 0x00000000, 0x00000000
    .long 0x0036ed00, 0x003eed00, 0x00513000, 0x0000050e, 0x00000000, 0x00000000, 0x00000000, 0x00000000
    .long 0x0036ee00, 0x003eee00, 0x00513000, 0x0000050e, 0x00000000, 0x00000000, 0x00000000, 0x00000000
    .long 0x0036e100, 0x003ee100, 0x00513000, 0x0000050e, 0x00000000, 0x00000000, 0x00000000, 0x00000000
    .long 0x0036e200, 0x003ee200, 0x00513000, 0x0000050e, 0x00000000, 0x00000000, 0x00000000, 0x00000000
    .long 0x0036e500, 0x003ee500, 0x00513000, 0x0000050e, 0x00000000, 0x00000000, 0x00000000, 0x00000000
    .long 0x0036e600, 0x003ee600, 0x00513000, 0x0000050e, 0x00000000, 0x00000000, 0x00000000, 0x00000000
    .long 0x0036e900, 0x003ee900, 0x00513000, 0x0000050e, 0x00000000, 0x00000000, 0x00000000, 0x00000000
    .long 0x0036ea00, 0x003eea00, 0x00513000, 0x0000050e, 0x00000000, 0x00000000, 0x00000000, 0x00000000
    .long 0x0036ed00, 0x0046ed00, 0x00513000, 0x0000050e, 0x00000000, 0x00000000, 0x00000000, 0x00000000
    .long 0x0036ee00, 0x0046ee00, 0x00513000, 0x0000050e, 0x00000000, 0x00000000, 0x00000000, 0x00000000
    .long 0x0036e100, 0x0046e100, 0x00513000, 0x0000050e, 0x00000000, 0x00000000, 0x00000000, 0x00000000
    .long 0x0036e200, 0x0046e200, 0x00513000, 0x0000050e, 0x00000000, 0x00000000, 0x00000000, 0x00000000
    .long 0x0036e500, 0x0046e500, 0x00513000, 0x0000050e, 0x00000000, 0x00000000, 0x00000000, 0x00000000
    .long 0x0036e600, 0x0046e600, 0x00513000, 0x0000050e, 0x00000000, 0x00000000, 0x00000000, 0x00000000
    .long 0x0036e900, 0x0046e900, 0x00513000, 0x0000050e, 0x00000000, 0x00000000, 0x00000000, 0x00000000
    .long 0x0036ea00, 0x0046ea00, 0x00513000, 0x0000050e, 0x00000000, 0x00000000, 0x00000000, 0x00000000
    .long 0x00afad00, 0x00afad00, 0x00cb0000, 0x0000160e, 0x00000000, 0x00000000, 0x00000000, 0x00000000
    .long 0x0036ef00, 0x0036ef00, 0x00513000, 0x0000050e, 0x00000000, 0x00000000, 0x00000000, 0x00000000
    .long 0x00afa100, 0x00afa100, 0x00cb0000, 0x0000160e, 0x00000000, 0x00000000, 0x00000000, 0x00000000
    .long 0x0036e300, 0x0036e300, 0x00513000, 0x0000050e, 0x00000000, 0x00000000, 0x00000000, 0x00000000
    .long 0x00afa500, 0x00afa500, 0x00cb0000, 0x0000160e, 0x00000000, 0x00000000, 0x00000000, 0x00000000
    .long 0x0036e700, 0x0036e700, 0x00513000, 0x0000050e, 0x00000000, 0x00000000, 0x00000000, 0x00000000
    .long 0x00afa900, 0x00afa900, 0x00cb0000, 0x0000160e, 0x00000000, 0x00000000, 0x00000000, 0x00000000
    .long 0x0036eb00, 0x0036eb00, 0x00513000, 0x0000050e, 0x00000000, 0x00000000, 0x00000000, 0x00000000
    .long 0x00afad00, 0x00b7ad00, 0x00cb0000, 0x0000160e, 0x00000000, 0x00000000, 0x00000000, 0x00000000
    .long 0x0036ef00, 0x003eef00, 0x00513000, 0x0000050e, 0x00000000, 0x00000000, 0x00000000, 0x00000000
    .long 0x00afa100, 0x00b7a100, 0x00cb0000, 0x0000160e, 0x00000000, 0x00000000, 0x00000000, 0x00000000
    .long 0x0036e300, 0x003ee300, 0x00513000, 0x0000050e, 0x00000000, 0x00000000, 0x00000000, 0x00000000
    .long 0x00afa500, 0x00b7a500, 0x00cb0000, 0x0000160e, 0x00000000, 0x00000000, 0x00000000, 0x00000000
    .long 0x0036e700, 0x003ee700, 0x00513000, 0x0000050e, 0x00000000, 0x00000000, 0x00000000, 0x00000000
    .long 0x00afa900, 0x00b7a900, 0x00cb0000, 0x0000160e, 0x00000000, 0x00000000, 0x00000000, 0x00000000
    .long 0x0036eb00, 0x003eeb00, 0x00513000, 0x0000050e, 0x00000000, 0x00000000, 0x00000000, 0x00000000
    .long 0x00afad00, 0x00bfad00, 0x00cb0000, 0x0000160e, 0x00000000, 0x00000000, 0x00000000, 0x00000000
    .long 0x0036ef00, 0x0046ef00, 0x00513000, 0x0000050e, 0x00000000, 0x00000000, 0x00000000, 0x00000000
    .long 0x00afa100, 0x00bfa100, 0x00cb0000, 0x0000160e, 0x00000000, 0x00000000, 0x00000000, 0x00000000
    .long 0x0036e300, 0x0046e300, 0x00513000, 0x0000050e, 0x00000000, 0x00000000, 0x00000000, 0x00000000
    .long 0x00afa500, 0x00bfa500, 0x00cb0000, 0x0000160e, 0x00000000, 0x00000000, 0x00000000, 0x00000000
    .long 0x0036e700, 0x0046e700, 0x00513000, 0x0000050e, 0x00000000, 0x00000000, 0x00000000, 0x00000000
    .long 0x00afa900, 0x00bfa900, 0x00cb0000, 0x0000160e, 0x00000000, 0x00000000, 0x00000000, 0x00000000
    .long 0x0036eb00, 0x0046eb00, 0x00513000, 0x0000050e, 0x00000000, 0x00000000, 0x00000000, 0x00000000
    .long 0x0036ec00, 0x0036ec00, 0x00513000, 0x0000050e, 0x00000000, 0x00000000, 0x00000000, 0x00000000
    .long 0x00afae00, 0x00afae00, 0x00cb0000, 0x0000160e, 0x00000000, 0x00000000, 0x00000000, 0x00000000
    .long 0x0036e000, 0x0036e000, 0x00513000, 0x0000050e, 0x00000000, 0x00000000, 0x00000000, 0x00000000
    .long 0x00afa200, 0x00afa200, 0x00cb0000, 0x0000160e, 0x00000000, 0x00000000, 0x00000000, 0x00000000
    .long 0x0036e400, 0x0036e400, 0x00513000, 0x0000050e, 0x00000000, 0x00000000, 0x00000000, 0x00000000
    .long 0x00afa600, 0x00afa600, 0x00cb0000, 0x0000160e, 0x00000000, 0x00000000, 0x00000000, 0x00000000
    .long 0x0036e800, 0x0036e800, 0x00513000, 0x0000050e, 0x00000000, 0x00000000, 0x00000000, 0x00000000
    .long 0x00afaa00, 0x00afaa00, 0x00cb0000, 0x0000160e, 0x00000000, 0x00000000, 0x00000000, 0x00000000
    .long 0x0036ec00, 0x003eec00, 0x00513000, 0x0000050e, 0x00000000, 0x00000000, 0x00000000, 0x00000000
    .long 0x00afae00, 0x00b7ae00, 0x00cb0000, 0x0000160e, 0x00000000, 0x00000000, 0x00000000, 0x00000000
    .long 0x0036e000, 0x003ee000, 0x00513000, 0x0000050e, 0x00000000, 0x00000000, 0x00000000, 0x00000000
    .long 0x00afa200, 0x00b7a200, 0x00cb0000, 0x0000160e, 0x00000000, 0x00000000, 0x00000000, 0x00000000
    .long 0x0036e400, 0x003ee400, 0x00513000, 0x0000050e, 0x00000000, 0x00000000, 0x00000000, 0x00000000
    .long 0x00afa600, 0x00b7a600, 0x00cb0000, 0x0000160e, 0x00000000, 0x00000000, 0x00000000, 0x00000000
    .long 0x0036e800, 0x003ee800, 0x00513000, 0x0000050e, 0x00000000, 0x00000000, 0x00000000, 0x00000000
    .long 0x00afaa00, 0x00b7aa00, 0x00cb0000, 0x0000160e, 0x00000000, 0x00000000, 0x00000000, 0x00000000
    .long 0x0036ec00, 0x0046ec00, 0x00513000, 0x0000050e, 0x00000000, 0x00000000, 0x00000000, 0x00000000
    .long 0x00afae00, 0x00bfae00, 0x00cb0000, 0x0000160e, 0x00000000, 0x00000000, 0x00000000, 0x00000000
    .long 0x0036e000, 0x0046e000, 0x00513000, 0x0000050e, 0x00000000, 0x00000000, 0x00000000, 0x00000000
    .long 0x00afa200, 0x00bfa200, 0x00cb0000, 0x0000160e, 0x00000000, 0x00000000, 0x00000000, 0x00000000
    .long 0x0036e400, 0x0046e400, 0x00513000, 0x0000050e, 0x00000000, 0x00000000, 0x00000000, 0x00000000
    .long 0x00afa600, 0x00bfa600, 0x00cb0000, 0x0000160e, 0x00000000, 0x00000000, 0x00000000, 0x00000000
    .long 0x0036e800, 0x0046e800, 0x00513000, 0x0000050e, 0x00000000, 0x00000000, 0x00000000, 0x00000000
    .long 0x00afaa00, 0x00bfaa00, 0x00cb0000, 0x0000160e, 0x00000000, 0x00000000, 0x00000000, 0x00000000
    .long 0x00afac00, 0x00afac00, 0x00cb0000, 0x0000160e, 0x00000000, 0x00000000, 0x00000000, 0x00000000
    .long 0x00afaf00, 0x00afaf00, 0x00cb0000, 0x0000160e, 0x00000000, 0x00000000, 0x00000000, 0x00000000
    .long 0x00afa000, 0x00afa000, 0x00cb0000, 0x0000160e, 0x00000000, 0x00000000, 0x00000000, 0x00000000
    .long 0x00afa300, 0x00afa300, 0x00cb0000, 0x0000160e, 0x00000000, 0x00000000, 0x00000000, 0x00000000
    .long 0x00afa400, 0x00afa400, 0x00cb0000, 0x0000160e, 0x00000000, 0x00000000, 0x00000000, 0x00000000
    .long 0x00afa700, 0x00afa700, 0x00cb0000, 0x0000160e, 0x00000000, 0x00000000, 0x00000000, 0x00000000
    .long 0x00afa800, 0x00afa800, 0x00cb0000, 0x0000160e, 0x00000000, 0x00000000, 0x00000000, 0x00000000
    .long 0x00afab00, 0x00afab00, 0x00cb0000, 0x0000160e, 0x00000000, 0x00000000, 0x00000000, 0x00000000
    .long 0x00afac00, 0x00b7ac00, 0x00cb0000, 0x0000160e, 0x00000000, 0x00000000, 0x00000000, 0x00000000
    .long 0x00afaf00, 0x00b7af00, 0x00cb0000, 0x0000160e, 0x00000000, 0x00000000, 0x00000000, 0x00000000
    .long 0x00afa000, 0x00b7a000, 0x00cb0000, 0x0000160e, 0x00000000, 0x00000000, 0x00000000, 0x00000000
    .long 0x00afa300, 0x00b7a300, 0x00cb0000, 0x0000160e, 0x00000000, 0x00000000, 0x00000000, 0x00000000
    .long 0x00afa400, 0x00b7a400, 0x00cb0000, 0x0000160e, 0x00000000, 0x00000000, 0x00000000, 0x00000000
    .long 0x00afa700, 0x00b7a700, 0x00cb0000, 0x0000160e, 0x00000000, 0x00000000, 0x00000000, 0x00000000
    .long 0x00afa800, 0x00b7a800, 0x00cb0000, 0x0000160e, 0x00000000, 0x00000000, 0x00000000, 0x00000000
    .long 0x00afab00, 0x00b7ab00, 0x00cb0000, 0x0000160e, 0x00000000, 0x00000000, 0x00000000, 0x00000000
    .long 0x00afac00, 0x00bfac00, 0x00cb0000, 0x0000160e, 0x00000000, 0x00000000, 0x00000000, 0x00000000
    .long 0x00afaf00, 0x00bfaf00, 0x00cb0000, 0x0000160e, 0x00000000, 0x00000000, 0x00000000, 0x00000000
    .long 0x00afa000, 0x00bfa000, 0x00cb0000, 0x0000160e, 0x00000000, 0x00000000, 0x00000000, 0x00000000
    .long 0x00afa300, 0x00bfa300, 0x00cb0000, 0x0000160e, 0x00000000, 0x00000000, 0x00000000, 0x00000000
    .long 0x00afa400, 0x00bfa400, 0x00cb0000, 0x0000160e, 0x00000000, 0x00000000, 0x00000000, 0x00000000
    .long 0x00afa700, 0x00bfa700, 0x00cb0000, 0x0000160e, 0x00000000, 0x00000000, 0x00000000, 0x00000000
    .long 0x00afa800, 0x00bfa800, 0x00cb0000, 0x0000160e, 0x00000000, 0x00000000, 0x00000000, 0x00000000
    .long 0x00afab00, 0x00bfab00, 0x00cb0000, 0x0000160e, 0x00000000, 0x00000000, 0x00000000, 0x00000000
    .long 0x00a56800, 0x00ad6800, 0x00afa000, 0x00000406, 0x00756d00, 0x00856d00, 0x00885000, 0x00000f0a
    .long 0x00ee3b00, 0x00ee3b00, 0x01049000, 0x0000060c, 0x00000000, 0x00000000, 0x00000000, 0x00000000
    .long 0x00a56c00, 0x00ad6c00, 0x00afa000, 0x00000406, 0x00756100, 0x00856100, 0x00885000, 0x00000f0a
    .long 0x00ee3f00, 0x00ee3f00, 0x01049000, 0x0000060c, 0x00000000, 0x00000000, 0x00000000, 0x00000000
    .long 0x00a56000, 0x00ad6000, 0x00afa000, 0x00000406, 0x00756500, 0x00856500, 0x00885000, 0x00000f0a
    .long 0x00ee3300, 0x00ee3300, 0x01049000, 0x0000060c, 0x00000000, 0x00000000, 0x00000000, 0x00000000
    .long 0x00a56400, 0x00ad6400, 0x00afa000, 0x00000406, 0x00756900, 0x00856900, 0x00885000, 0x00000f0a
    .long 0x00ee3700, 0x00ee3700, 0x01049000, 0x0000060c, 0x00000000, 0x00000000, 0x00000000, 0x00000000
    .long 0x00a56a00, 0x00ad6a00, 0x00afa000, 0x00000406, 0x0092f500, 0x00a2f500, 0x00a56000, 0x0000070a
    .long 0x00ee3b00, 0x00f63b00, 0x01049000, 0x0000060c, 0x00000000, 0x00000000, 0x00000000, 0x00000000
    .long 0x00a56e00, 0x00ad6e00, 0x00afa000, 0x00000406, 0x0092f900, 0x00a2f900, 0x00a56000, 0x0000070a
    .long 0x00ee3f00, 0x00f63f00, 0x01049000, 0x0000060c, 0x00000000, 0x00000000, 0x00000000, 0x00000000
    .long 0x00a56200, 0x00ad6200, 0x00afa000, 0x00000406, 0x0092fd00, 0x00a2fd00, 0x00a56000, 0x0000070a
    .long 0x00ee3300, 0x00f63300, 0x01049000, 0x0000060c, 0x00000000, 0x00000000, 0x00000000, 0x00000000
    .long 0x00a56600, 0x00ad6600, 0x00afa000, 0x00000406, 0x0092f100, 0x00a2f100, 0x00a56000, 0x0000070a
    .long 0x00ee3700, 0x00f63700, 0x01049000, 0x0000060c, 0x00000000, 0x00000000, 0x00000000, 0x00000000
    .long 0x00756c00, 0x00856c00, 0x00885000, 0x00000f0a, 0x00885000, 0x00905000, 0x0092f000, 0x00000a06
    .long 0x00ee3b00, 0x00fe3b00, 0x01049000, 0x0000060c, 0x00000000, 0x00000000, 0x00000000, 0x00000000
    .long 0x00756000, 0x00856000, 0x00885000, 0x00000f0a, 0x00885400, 0x00905400, 0x0092f000, 0x00000a06
    .long 0x00ee3f00, 0x00fe3f00, 0x01049000, 0x0000060c, 0x00000000, 0x00000000, 0x00000000, 0x00000000
    .long 0x00756400, 0x00856400, 0x00885000, 0x00000f0a, 0x00885800, 0x00905800, 0x0092f000, 0x00000a06
    .long 0x00ee3300, 0x00fe3300, 0x01049000, 0x0000060c, 0x00000000, 0x00000000, 0x00000000, 0x00000000
    .long 0x00756800, 0x00856800, 0x00885000, 0x00000f0a, 0x00885c00, 0x00905c00, 0x0092f000, 0x00000a06
    .long 0x00ee3700, 0x00fe3700, 0x01049000, 0x0000060c, 0x00000000, 0x00000000, 0x00000000, 0x00000000
    .long 0x0092f400, 0x00a2f400, 0x00a56000, 0x0000070a, 0x00885200, 0x00905200, 0x0092f000, 0x00000a06
    .long 0x00000300, 0x00000300, 0x00141000, 0x0000010b, 0x00000000, 0x00000000, 0x00000000, 0x00000000
    .long 0x0092f800, 0x00a2f800, 0x00a56000, 0x0000070a, 0x00885600, 0x00905600, 0x0092f000, 0x00000a06
    .long 0x00000700, 0x00000700, 0x00141000, 0x0000010b, 0x00000000, 0x00000000, 0x00000000, 0x00000000
    .long 0x0092fc00, 0x00a2fc00, 0x00a56000, 0x0000070a, 0x00885a00, 0x00905a00, 0x0092f000, 0x00000a06
    .long 0x00000b00, 0x00000b00, 0x00141000, 0x0000010b, 0x00000000, 0x00000000, 0x00000000, 0x00000000
    .long 0x0092f000, 0x00a2f000, 0x00a56000, 0x0000070a, 0x00885e00, 0x00905e00, 0x0092f000, 0x00000a06
    .long 0x00000f00, 0x00000f00, 0x00141000, 0x0000010b, 0x00000000, 0x00000000, 0x00000000, 0x00000000
    .long 0x00a56800, 0x00a56800, 0x00afa000, 0x00000406, 0x00756d00, 0x00756d00, 0x00885000, 0x00000f0a
    .long 0x00756e00, 0x00856e00, 0x00885000, 0x00000f0a, 0x00885100, 0x00905100, 0x0092f000, 0x00000a06
    .long 0x00a56c00, 0x00a56c00, 0x00afa000, 0x00000406, 0x00756100, 0x00756100, 0x00885000, 0x00000f0a
    .long 0x00756200, 0x00856200, 0x00885000, 0x00000f0a, 0x00885500, 0x00905500, 0x0092f000, 0x00000a06
    .long 0x00a56000, 0x00a56000, 0x00afa000, 0x00000406, 0x00756500, 0x00756500, 0x00885000, 0x00000f0a
    .long 0x00756600, 0x00856600, 0x00885000, 0x00000f0a, 0x00885900, 0x00905900, 0x0092f000, 0x00000a06
    .long 0x00a56400, 0x00a56400, 0x00afa000, 0x00000406, 0x00756900, 0x00756900, 0x00885000, 0x00000f0a
    .long 0x00756a00, 0x00856a00, 0x00885000, 0x00000f0a, 0x00885d00, 0x00905d00, 0x0092f000, 0x00000a06
    .long 0x00a56a00, 0x00a56a00, 0x00afa000, 0x00000406, 0x00756d00, 0x007d6d00, 0x00885000, 0x00000f0a
    .long 0x00756f00, 0x00856f00, 0x00885000, 0x00000f0a, 0x00a56900, 0x00ad6900, 0x00afa000, 0x00000406
    .long 0x00a56e00, 0x00a56e00, 0x00afa000, 0x00000406, 0x00756100, 0x007d6100, 0x00885000, 0x00000f0a
    .long 0x00756300, 0x00856300, 0x00885000, 0x00000f0a, 0x00a56d00, 0x00ad6d00, 0x00afa000, 0x00000406
    .long 0x00a56200, 0x00a56200, 0x00afa000, 0x00000406, 0x00756500, 0x007d6500, 0x00885000, 0x00000f0a
    .long 0x00756700, 0x00856700, 0x00885000, 0x00000f0a, 0x00a56100, 0x00ad6100, 0x00afa000, 0x00000406
    .long 0x00a56600, 0x00a56600, 0x00afa000, 0x00000406, 0x00756900, 0x007d6900, 0x00885000, 0x00000f0a
    .long 0x00756b00, 0x00856b00, 0x00885000, 0x00000f0a, 0x00a56500, 0x00ad6500, 0x00afa000, 0x00000406
    .long 0x00141400, 0x00141400, 0x0022b000, 0x00000a08, 0x00cb0000, 0x00d30000, 0x00d8f000, 0x00001f07
    .long 0x0092f600, 0x00a2f600, 0x00a56000, 0x0000070a, 0x00885300, 0x00905300, 0x0092f000, 0x00000a06
    .long 0x00141800, 0x00141800, 0x0022b000, 0x00000a08, 0x00cb0400, 0x00d30400, 0x00d8f000, 0x00001f07
    .long 0x0092fa00, 0x00a2fa00, 0x00a56000, 0x0000070a, 0x00885700, 0x00905700, 0x0092f000, 0x00000a06
    .long 0x00141c00, 0x00141c00, 0x0022b000, 0x00000a08, 0x00cb0800, 0x00d30800, 0x00d8f000, 0x00001f07
    .long 0x0092fe00, 0x00a2fe00, 0x00a56000, 0x0000070a, 0x00885b00, 0x00905b00, 0x0092f000, 0x00000a06
    .long 0x00141000, 0x00141000, 0x0022b000, 0x00000a08, 0x00cb0c00, 0x00d30c00, 0x00d8f000, 0x00001f07
    .long 0x0092f200, 0x00a2f200, 0x00a56000, 0x0000070a, 0x00885f00, 0x00905f00, 0x0092f000, 0x00000a06
    .long 0x00141400, 0x001c1400, 0x0022b000, 0x00000a08, 0x00686800, 0x00706800, 0x00756000, 0x00001007
    .long 0x0092f700, 0x00a2f700, 0x00a56000, 0x0000070a, 0x00a56b00, 0x00ad6b00, 0x00afa000, 0x00000406
    .long 0x00141800, 0x001c1800, 0x0022b000, 0x00000a08, 0x00686c00, 0x00706c00, 0x00756000, 0x00001007
    .long 0x0092fb00, 0x00a2fb00, 0x00a56000, 0x0000070a, 0x00a56f00, 0x00ad6f00, 0x00afa000, 0x00000406
    .long 0x00141c00, 0x001c1c00, 0x0022b000, 0x00000a08, 0x00686000, 0x00706000, 0x00756000, 0x00001007
    .long 0x0092ff00, 0x00a2ff00, 0x00a56000, 0x0000070a, 0x00a56300, 0x00ad6300, 0x00afa000, 0x00000406
    .long 0x00141000, 0x001c1000, 0x0022b000, 0x00000a08, 0x00686400, 0x00706400, 0x00756000, 0x00001007
    .long 0x0092f300, 0x00a2f300, 0x00a56000, 0x0000070a, 0x00a56700, 0x00ad6700, 0x00afa000, 0x00000406
    .long 0x00513000, 0x00513000, 0x0060f000, 0x00001c08, 0x00686a00, 0x00686a00, 0x00756000, 0x00001007
    .long 0x00686b00, 0x00686b00, 0x00756000, 0x00001007, 0x00686900, 0x00706900, 0x00756000, 0x00001007
    .long 0x00513400, 0x00513400, 0x0060f000, 0x00001c08, 0x00686e00, 0x00686e00, 0x00756000, 0x00001007
    .long 0x00686f00, 0x00686f00, 0x00756000, 0x00001007, 0x00686d00, 0x00706d00, 0x00756000, 0x00001007
    .long 0x00513800, 0x00513800, 0x0060f000, 0x00001c08, 0x00686200, 0x00686200, 0x00756000, 0x00001007
    .long 0x00686300, 0x00686300, 0x00756000, 0x00001007, 0x00686100, 0x00706100, 0x00756000, 0x00001007
    .long 0x00513c00, 0x00513c00, 0x0060f000, 0x00001c08, 0x00686600, 0x00686600, 0x00756000, 0x00001007
    .long 0x00686700, 0x00686700, 0x00756000, 0x00001007, 0x00686500, 0x00706500, 0x00756000, 0x00001007
    .long 0x00513000, 0x00593000, 0x0060f000, 0x00001c08, 0x00686a00, 0x00706a00, 0x00756000, 0x00001007
    .long 0x00686b00, 0x00706b00, 0x00756000, 0x00001007, 0x00686900, 0x00686900, 0x00756000, 0x00001007
    .long 0x00513400, 0x00593400, 0x0060f000, 0x00001c08, 0x00686e00, 0x00706e00, 0x00756000, 0x00001007
    .long 0x00686f00, 0x00706f00, 0x00756000, 0x00001007, 0x00686d00, 0x00686d00, 0x00756000, 0x00001007
    .long 0x00513800, 0x00593800, 0x0060f000, 0x00001c08, 0x00686200, 0x00706200, 0x00756000, 0x00001007
    .long 0x00686300, 0x00706300, 0x00756000, 0x00001007, 0x00686100, 0x00686100, 0x00756000, 0x00001007
    .long 0x00513c00, 0x00593c00, 0x0060f000, 0x00001c08, 0x00686600, 0x00706600, 0x00756000, 0x00001007
    .long 0x00686700, 0x00706700, 0x00756000, 0x00001007, 0x00686500, 0x00686500, 0x00756000, 0x00001007
    .long 0x00cb0200, 0x00cb0200, 0x00d8f000, 0x00001f07, 0x00141500, 0x00141500, 0x0022b000, 0x00000a08
    .long 0x00cb0300, 0x00cb0300, 0x00d8f000, 0x00001f07, 0x00cb0100, 0x00d30100, 0x00d8f000, 0x00001f07
    .long 0x00cb0600, 0x00cb0600, 0x00d8f000, 0x00001f07, 0x00141900, 0x00141900, 0x0022b000, 0x00000a08
    .long 0x00cb0700, 0x00cb0700, 0x00d8f000, 0x00001f07, 0x00cb0500, 0x00d30500, 0x00d8f000, 0x00001f07
    .long 0x00cb0a00, 0x00cb0a00, 0x00d8f000, 0x00001f07, 0x00141d00, 0x00141d00, 0x0022b000, 0x00000a08
    .long 0x00cb0b00, 0x00cb0b00, 0x00d8f000, 0x00001f07, 0x00cb0900, 0x00d30900, 0x00d8f000, 0x00001f07
    .long 0x00cb0e00, 0x00cb0e00, 0x00d8f000, 0x00001f07, 0x00141100, 0x00141100, 0x0022b000, 0x00000a08
    .long 0x00cb0f00, 0x00cb0f00, 0x00d8f000, 0x00001f07, 0x00cb0d00, 0x00d30d00, 0x00d8f000, 0x00001f07
    .long 0x00cb0200, 0x00d30200, 0x00d8f000, 0x00001f07, 0x00141500, 0x001c1500, 0x0022b000, 0x00000a08
    .long 0x00cb0300, 0x00d30300, 0x00d8f000, 0x00001f07, 0x00cb0100, 0x00cb0100, 0x00d8f000, 0x00001f07
    .long 0x00cb0600, 0x00d30600, 0x00d8f000, 0x00001f07, 0x00141900, 0x001c1900, 0x0022b000, 0x00000a08
    .long 0x00cb0700, 0x00d30700, 0x00d8f000, 0x00001f07, 0x00cb0500, 0x00cb0500, 0x00d8f000, 0x00001f07
    .long 0x00cb0a00, 0x00d30a00, 0x00d8f000, 0x00001f07, 0x00141d00, 0x001c1d00, 0x0022b000, 0x00000a08
    .long 0x00cb0b00, 0x00d30b00, 0x00d8f000, 0x00001f07, 0x00cb0900, 0x00cb0900, 0x00d8f000, 0x00001f07
    .long 0x00cb0e00, 0x00d30e00, 0x00d8f000, 0x00001f07, 0x00141100, 0x001c1100, 0x0022b000, 0x00000a08
    .long 0x00cb0f00, 0x00d30f00, 0x00d8f000, 0x00001f07, 0x00cb0d00, 0x00cb0d00, 0x00d8f000, 0x00001f07
    .long 0x01049c00, 0x01049c00, 0x01127000, 0x00001e07, 0x00513100, 0x00513100, 0x0060f000, 0x00001c08
    .long 0x01049f00, 0x01049f00, 0x01127000, 0x00001e07, 0x01049d00, 0x010c9d00, 0x01127000, 0x00001e07
    .long 0x01049000, 0x01049000, 0x01127000, 0x00001e07, 0x00513500, 0x00513500, 0x0060f000, 0x00001c08
    .long 0x01049300, 0x01049300, 0x01127000, 0x00001e07, 0x01049100, 0x010c9100, 0x01127000, 0x00001e07
    .long 0x01049400, 0x01049400, 0x01127000, 0x00001e07, 0x00513900, 0x00513900, 0x0060f000, 0x00001c08
    .long 0x01049700, 0x01049700, 0x01127000, 0x00001e07, 0x01049500, 0x010c9500, 0x01127000, 0x00001e07
    .long 0x01049800, 0x01049800, 0x01127000, 0x00001e07, 0x00513d00, 0x00513d00, 0x0060f000, 0x00001c08
    .long 0x01049b00, 0x01049b00, 0x01127000, 0x00001e07, 0x01049900, 0x010c9900, 0x01127000, 0x00001e07
    .long 0x01049c00, 0x010c9c00, 0x01127000, 0x00001e07, 0x00513100, 0x00593100, 0x0060f000, 0x00001c08
    .long 0x01049f00, 0x010c9f00, 0x01127000, 0x00001e07, 0x01049d00, 0x01049d00, 0x01127000, 0x00001e07
    .long 0x01049000, 0x010c9000, 0x01127000, 0x00001e07, 0x00513500, 0x00593500, 0x0060f000, 0x00001c08
    .long 0x01049300, 0x010c9300, 0x01127000, 0x00001e07, 0x01049100, 0x01049100, 0x01127000, 0x00001e07
    .long 0x01049400, 0x010c9400, 0x01127000, 0x00001e07, 0x00513900, 0x00593900, 0x0060f000, 0x00001c08
    .long 0x01049700, 0x010c9700, 0x01127000, 0x00001e07, 0x01049500, 0x01049500, 0x01127000, 0x00001e07
    .long 0x01049800, 0x010c9800, 0x01127000, 0x00001e07, 0x00513d00, 0x00593d00, 0x0060f000, 0x00001c08
    .long 0x01049b00, 0x010c9b00, 0x01127000, 0x00001e07, 0x01049900, 0x01049900, 0x01127000, 0x00001e07
    .long 0x00756c00, 0x00756c00, 0x00885000, 0x00000f0a, 0x0060f400, 0x0060f400, 0x00686000, 0x00001704
    .long 0x00141600, 0x00141600, 0x0022b000, 0x00000a08, 0x00885100, 0x00885100, 0x0092f000, 0x00000a06
    .long 0x00756000, 0x00756000, 0x00885000, 0x00000f0a, 0x0060f800, 0x0060f800, 0x00686000, 0x00001704
    .long 0x00141a00, 0x00141a00, 0x0022b000, 0x00000a08, 0x00885500, 0x00885500, 0x0092f000, 0x00000a06
    .long 0x00756400, 0x00756400, 0x00885000, 0x00000f0a, 0x0060fc00, 0x0060fc00, 0x00686000, 0x00001704
    .long 0x00141e00, 0x00141e00, 0x0022b000, 0x00000a08, 0x00885900, 0x00885900, 0x0092f000, 0x00000a06
    .long 0x00756800, 0x00756800, 0x00885000, 0x00000f0a, 0x0060f000, 0x0060f000, 0x00686000, 0x00001704
    .long 0x00141200, 0x00141200, 0x0022b000, 0x00000a08, 0x00885d00, 0x00885d00, 0x0092f000, 0x00000a06
    .long 0x00756c00, 0x007d6c00, 0x00885000, 0x00000f0a, 0x0060f600, 0x0060f600, 0x00686000, 0x00001704
    .long 0x00141600, 0x001c1600, 0x0022b000, 0x00000a08, 0x00a56900, 0x00a56900, 0x00afa000, 0x00000406
    .long 0x00756000, 0x007d6000, 0x00885000, 0x00000f0a, 0x0060fa00, 0x0060fa00, 0x00686000, 0x00001704
    .long 0x00141a00, 0x001c1a00, 0x0022b000, 0x00000a08, 0x00a56d00, 0x00a56d00, 0x00afa000, 0x00000406
    .long 0x00756400, 0x007d6400, 0x00885000, 0x00000f0a, 0x0060fe00, 0x0060fe00, 0x00686000, 0x00001704
    .long 0x00141e00, 0x001c1e00, 0x0022b000, 0x00000a08, 0x00a56100, 0x00a56100, 0x00afa000, 0x00000406
    .long 0x00756800, 0x007d6800, 0x00885000, 0x00000f0a, 0x0060f200, 0x0060f200, 0x00686000, 0x00001704
    .long 0x00141200, 0x001c1200, 0x0022b000, 0x00000a08, 0x00a56500, 0x00a56500, 0x00afa000, 0x00000406
    .long 0x00513200, 0x00513200, 0x0060f000, 0x00001c08, 0x00885000, 0x00885000, 0x0092f000, 0x00000a06
    .long 0x00141700, 0x00141700, 0x0022b000, 0x00000a08, 0x00885300, 0x00885300, 0x0092f000, 0x00000a06
    .long 0x00513600, 0x00513600, 0x0060f000, 0x00001c08, 0x00885400, 0x00885400, 0x0092f000, 0x00000a06
    .long 0x00141b00, 0x00141b00, 0x0022b000, 0x00000a08, 0x00885700, 0x00885700, 0x0092f000, 0x00000a06
    .long 0x00513a00, 0x00513a00, 0x0060f000, 0x00001c08, 0x00885800, 0x00885800, 0x0092f000, 0x00000a06
    .long 0x00141f00, 0x00141f00, 0x0022b000, 0x00000a08, 0x00885b00, 0x00885b00, 0x0092f000, 0x00000a06
    .long 0x00513e00, 0x00513e00, 0x0060f000, 0x00001c08, 0x00885c00, 0x00885c00, 0x0092f000, 0x00000a06
    .long 0x00141300, 0x00141300, 0x0022b000, 0x00000a08, 0x00885f00, 0x00885f00, 0x0092f000, 0x00000a06
    .long 0x00513200, 0x00593200, 0x0060f000, 0x00001c08, 0x00885200, 0x00885200, 0x0092f000, 0x00000a06
    .long 0x00141700, 0x001c1700, 0x0022b000, 0x00000a08, 0x00a56b00, 0x00a56b00, 0x00afa000, 0x00000406
    .long 0x00513600, 0x00593600, 0x0060f000, 0x00001c08, 0x00885600, 0x00885600, 0x0092f000, 0x00000a06
    .long 0x00141b00, 0x001c1b00, 0x0022b000, 0x00000a08, 0x00a56f00, 0x00a56f00, 0x00afa000, 0x00000406
    .long 0x00513a00, 0x00593a00, 0x0060f000, 0x00001c08, 0x00885a00, 0x00885a00, 0x0092f000, 0x00000a06
    .long 0x00141f00, 0x001c1f00, 0x0022b000, 0x00000a08, 0x00a56300, 0x00a56300, 0x00afa000, 0x00000406
    .long 0x00513e00, 0x00593e00, 0x0060f000, 0x00001c08, 0x00885e00, 0x00885e00, 0x0092f000, 0x00000a06
    .long 0x00141300, 0x001c1300, 0x0022b000, 0x00000a08, 0x00a56700, 0x00a56700, 0x00afa000, 0x00000406
    .long 0x01049e00, 0x010c9e00, 0x01127000, 0x00001e07, 0x00cb0000, 0x00cb0000, 0x00d8f000, 0x00001f07
    .long 0x00513300, 0x00513300, 0x0060f000, 0x00001c08, 0x0060f700, 0x0060f700, 0x00686000, 0x00001704
    .long 0x01049200, 0x010c9200, 0x01127000, 0x00001e07, 0x00cb0400, 0x00cb0400, 0x00d8f000, 0x00001f07
    .long 0x00513700, 0x00513700, 0x0060f000, 0x00001c08, 0x0060fb00, 0x0060fb00, 0x00686000, 0x00001704
    .long 0x01049600, 0x010c9600, 0x01127000, 0x00001e07, 0x00cb0800, 0x00cb0800, 0x00d8f000, 0x00001f07
    .long 0x00513b00, 0x00513b00, 0x0060f000, 0x00001c08, 0x0060ff00, 0x0060ff00, 0x00686000, 0x00001704
    .long 0x01049a00, 0x010c9a00, 0x01127000, 0x00001e07, 0x00cb0c00, 0x00cb0c00, 0x00d8f000, 0x00001f07
    .long 0x00513f00, 0x00513f00, 0x0060f000, 0x00001c08, 0x0060f300, 0x0060f300, 0x00686000, 0x00001704
    .long 0x01049e00, 0x01049e00, 0x01127000, 0x00001e07, 0x00686800, 0x00686800, 0x00756000, 0x00001007
    .long 0x00513300, 0x00593300, 0x0060f000, 0x00001c08, 0x0060f500, 0x0060f500, 0x00686000, 0x00001704
    .long 0x01049200, 0x01049200, 0x01127000, 0x00001e07, 0x00686c00, 0x00686c00, 0x00756000, 0x00001007
    .long 0x00513700, 0x00593700, 0x0060f000, 0x00001c08, 0x0060f900, 0x0060f900, 0x00686000, 0x00001704
    .long 0x01049600, 0x01049600, 0x01127000, 0x00001e07, 0x00686000, 0x00686000, 0x00756000, 0x00001007
    .long 0x00513b00, 0x00593b00, 0x0060f000, 0x00001c08, 0x0060fd00, 0x0060fd00, 0x00686000, 0x00001704
    .long 0x01049a00, 0x01049a00, 0x01127000, 0x00001e07, 0x00686400, 0x00686400, 0x00756000, 0x00001007
    .long 0x00513f00, 0x00593f00, 0x0060f000, 0x00001c08, 0x0060f100, 0x0060f100, 0x00686000, 0x00001704
    .long 0x00ee3800, 0x00ee3800, 0x01049000, 0x0710060c, 0x00000000, 0x00000000, 0x00000000, 0x00000000
    .long 0x00000100, 0x00000100, 0x00141000, 0x0f10010b, 0x00000000, 0x00000000, 0x00000000, 0x00000000
    .long 0x00ee3c00, 0x00ee3c00, 0x01049000, 0x0710060c, 0x00000000, 0x00000000, 0x00000000, 0x00000000
    .long 0x00000500, 0x00000500, 0x00141000, 0x0f10010b, 0x00000000, 0x00000000, 0x00000000, 0x00000000
    .long 0x00ee3000, 0x00ee3000, 0x01049000, 0x0710060c, 0x00000000, 0x00000000, 0x00000000, 0x00000000
    .long 0x00000900, 0x00000900, 0x00141000, 0x0f10010b, 0x00000000, 0x00000000, 0x00000000, 0x00000000
    .long 0x00ee3400, 0x00ee3400, 0x01049000, 0x0710060c, 0x00000000, 0x00000000, 0x00000000, 0x00000000
    .long 0x00000d00, 0x00000d00, 0x00141000, 0x0f10010b, 0x00000000, 0x00000000, 0x00000000, 0x00000000
    .long 0x00ee3800, 0x00f63800, 0x01049000, 0x0710060c, 0x00000000, 0x00000000, 0x00000000, 0x00000000
    .long 0x00000100, 0x00080100, 0x00141000, 0x0f10010b, 0x00000000, 0x00000000, 0x00000000, 0x00000000
    .long 0x00ee3c00, 0x00f63c00, 0x01049000, 0x0710060c, 0x00000000, 0x00000000, 0x00000000, 0x00000000
    .long 0x00000500, 0x00080500, 0x00141000, 0x0f10010b, 0x00000000, 0x00000000, 0x00000000, 0x00000000
    .long 0x00ee3000, 0x00f63000, 0x01049000, 0x0710060c, 0x00000000, 0x00000000, 0x00000000, 0x00000000
    .long 0x00000900, 0x00080900, 0x00141000, 0x0f10010b, 0x00000000, 0x00000000, 0x00000000, 0x00000000
    .long 0x00ee3400, 0x00f63400, 0x01049000, 0x0710060c, 0x00000000, 0x00000000, 0x00000000, 0x00000000
    .long 0x00000d00, 0x00080d00, 0x00141000, 0x0f10010b, 0x00000000, 0x00000000, 0x00000000, 0x00000000
    .long 0x00ee3800, 0x00fe3800, 0x01049000, 0x0710060c, 0x00000000, 0x00000000, 0x00000000, 0x00000000
    .long 0x00000100, 0x00100100, 0x00141000, 0x0f10010b, 0x00000000, 0x00000000, 0x00000000, 0x00000000
    .long 0x00ee3c00, 0x00fe3c00, 0x01049000, 0x0710060c, 0x00000000, 0x00000000, 0x00000000, 0x00000000
    .long 0x00000500, 0x00100500, 0x00141000, 0x0f10010b, 0x00000000, 0x00000000, 0x00000000, 0x00000000
    .long 0x00ee3000, 0x00fe3000, 0x01049000, 0x0710060c, 0x00000000, 0x00000000, 0x00000000, 0x00000000
    .long 0x00000900, 0x00100900, 0x00141000, 0x0f10010b, 0x00000000, 0x00000000, 0x00000000, 0x00000000
    .long 0x00ee3400, 0x00fe3400, 0x01049000, 0x0710060c, 0x00000000, 0x00000000, 0x00000000, 0x00000000
    .long 0x00000d00, 0x00100d00, 0x00141000, 0x0f10010b, 0x00000000, 0x00000000, 0x00000000, 0x00000000
    .long 0x00000000, 0x00000000, 0x00141000, 0x0f10010b, 0x00000000, 0x00000000, 0x00000000, 0x00000000
    .long 0x00d8f500, 0x00d8f500, 0x00ee3000, 0x0f10140b, 0x00000000, 0x00000000, 0x00000000, 0x00000000
    .long 0x00000400, 0x00000400, 0x00141000, 0x0f10010b, 0x00000000, 0x00000000, 0x00000000, 0x00000000
    .long 0x00d8f900, 0x00d8f900, 0x00ee3000, 0x0f10140b, 0x00000000, 0x00000000, 0x00000000, 0x00000000
    .long 0x00000800, 0x00000800, 0x00141000, 0x0f10010b, 0x00000000, 0x00000000, 0x00000000, 0x00000000
    .long 0x00d8fd00, 0x00d8fd00, 0x00ee3000, 0x0f10140b, 0x00000000, 0x00000000, 0x00000000, 0x00000000
    .long 0x00000c00, 0x00000c00, 0x00141000, 0x0f10010b, 0x00000000, 0x00000000, 0x00000000, 0x00000000
    .long 0x00d8f100, 0x00d8f100, 0x00ee3000, 0x0f10140b, 0x00000000, 0x00000000, 0x00000000, 0x00000000
    .long 0x00000000, 0x00080000, 0x00141000, 0x0f10010b, 0x00000000, 0x00000000, 0x00000000, 0x00000000
    .long 0x00d8f500, 0x00e0f500, 0x00ee3000, 0x0f10140b, 0x00000000, 0x00000000, 0x00000000, 0x00000000
    .long 0x00000400, 0x00080400, 0x00141000, 0x0f10010b, 0x00000000, 0x00000000, 0x00000000, 0x00000000
    .long 0x00d8f900, 0x00e0f900, 0x00ee3000, 0x0f10140b, 0x00000000, 0x00000000, 0x00000000, 0x00000000
    .long 0x00000800, 0x00080800, 0x00141000, 0x0f10010b, 0x00000000, 0x00000000, 0x00000000, 0x00000000
    .long 0x00d8fd00, 0x00e0fd00, 0x00ee3000, 0x0f10140b, 0x00000000, 0x00000000, 0x00000000, 0x00000000
    .long 0x00000c00, 0x00080c00, 0x00141000, 0x0f10010b, 0x00000000, 0x00000000, 0x00000000, 0x00000000
    .long 0x00d8f100, 0x00e0f100, 0x00ee3000, 0x0f10140b, 0x00000000, 0x00000000, 0x00000000, 0x00000000
    .long 0x00000000, 0x00100000, 0x00141000, 0x0f10010b, 0x00000000, 0x00000000, 0x00000000, 0x00000000
    .long 0x00d8f500, 0x00e8f500, 0x00ee3000, 0x0f10140b, 0x00000000, 0x00000000, 0x00000000, 0x00000000
    .long 0x00000400, 0x00100400, 0x00141000, 0x0f10010b, 0x00000000, 0x00000000, 0x00000000, 0x00000000
    .long 0x00d8f900, 0x00e8f900, 0x00ee3000, 0x0f10140b, 0x00000000, 0x00000000, 0x00000000, 0x00000000
    .long 0x00000800, 0x00100800, 0x00141000, 0x0f10010b, 0x00000000, 0x00000000, 0x00000000, 0x00000000
    .long 0x00d8fd00, 0x00e8fd00, 0x00ee3000, 0x0f10140b, 0x00000000, 0x00000000, 0x00000000, 0x00000000
    .long 0x00000c00, 0x00100c00, 0x00141000, 0x0f10010b, 0x00000000, 0x00000000, 0x00000000, 0x00000000
    .long 0x00d8f100, 0x00e8f100, 0x00ee3000, 0x0f10140b, 0x00000000, 0x00000000, 0x00000000, 0x00000000
    .long 0x0022b900, 0x0022b900, 0x0036e000, 0x0f10030b, 0x00000000, 0x00000000, 0x00000000, 0x00000000
    .long 0x00000300, 0x00080300, 0x00141000, 0x0f10010b, 0x00000000, 0x00000000, 0x00000000, 0x00000000
    .long 0x0022bd00, 0x0022bd00, 0x0036e000, 0x0f10030b, 0x00000000, 0x00000000, 0x00000000, 0x00000000
    .long 0x00000700, 0x00080700, 0x00141000, 0x0f10010b, 0x00000000, 0x00000000, 0x00000000, 0x00000000
    .long 0x0022b100, 0x0022b100, 0x0036e000, 0x0f10030b, 0x00000000, 0x00000000, 0x00000000, 0x00000000
    .long 0x00000b00, 0x00080b00, 0x00141000, 0x0f10010b, 0x00000000, 0x00000000, 0x00000000, 0x00000000
    .long 0x0022b500, 0x0022b500, 0x0036e000, 0x0f10030b, 0x00000000, 0x00000000, 0x00000000, 0x00000000
    .long 0x00000f00, 0x00080f00, 0x00141000, 0x0f10010b, 0x00000000, 0x00000000, 0x00000000, 0x00000000
    .long 0x0022b900, 0x002ab900, 0x0036e000, 0x0f10030b, 0x00000000, 0x00000000, 0x00000000, 0x00000000
    .long 0x00d8f700, 0x00e0f700, 0x00ee3000, 0x0f10140b, 0x00000000, 0x00000000, 0x00000000, 0x00000000
    .long 0x0022bd00, 0x002abd00, 0x0036e000, 0x0f10030b, 0x00000000, 0x00000000, 0x00000000, 0x00000000
    .long 0x00d8fb00, 0x00e0fb00, 0x00ee3000, 0x0f10140b, 0x00000000, 0x00000000, 0x00000000, 0x00000000
    .long 0x0022b100, 0x002ab100, 0x0036e000, 0x0f10030b, 0x00000000, 0x00000000, 0x00000000, 0x00000000
    .long 0x00d8ff00, 0x00e0ff00, 0x00ee3000, 0x0f10140b, 0x00000000, 0x00000000, 0x00000000, 0x00000000
    .long 0x0022b500, 0x002ab500, 0x0036e000, 0x0f10030b, 0x00000000, 0x00000000, 0x00000000, 0x00000000
    .long 0x00d8f300, 0x00e0f300, 0x00ee3000, 0x0f10140b, 0x00000000, 0x00000000, 0x00000000, 0x00000000
    .long 0x0022b900, 0x0032b900, 0x0036e000, 0x0f10030b, 0x00000000, 0x00000000, 0x00000000, 0x00000000
    .long 0x0022ba00, 0x0022ba00, 0x0036e000, 0x0f10030b, 0x00000000, 0x00000000, 0x00000000, 0x00000000
    .long 0x0022bd00, 0x0032bd00, 0x0036e000, 0x0f10030b, 0x00000000, 0x00000000, 0x00000000, 0x00000000
    .long 0x0022be00, 0x0022be00, 0x0036e000, 0x0f10030b, 0x00000000, 0x00000000, 0x00000000, 0x00000000
    .long 0x0022b100, 0x0032b100, 0x0036e000, 0x0f10030b, 0x00000000, 0x00000000, 0x00000000, 0x00000000
    .long 0x0022b200, 0x0022b200, 0x0036e000, 0x0f10030b, 0x00000000, 0x00000000, 0x00000000, 0x00000000
    .long 0x0022b500, 0x0032b500, 0x0036e000, 0x0f10030b, 0x00000000, 0x00000000, 0x00000000, 0x00000000
    .long 0x0022b600, 0x0022b600, 0x0036e000, 0x0f10030b, 0x00000000, 0x00000000, 0x00000000, 0x00000000
    .long 0x00ee3a00, 0x00ee3a00, 0x01049000, 0x0f10060c, 0x00000000, 0x00000000, 0x00000000, 0x00000000
    .long 0x0022ba00, 0x002aba00, 0x0036e000, 0x0f10030b, 0x00000000, 0x00000000, 0x00000000, 0x00000000
    .long 0x00ee3e00, 0x00ee3e00, 0x01049000, 0x0f10060c, 0x00000000, 0x00000000, 0x00000000, 0x00000000
    .long 0x0022be00, 0x002abe00, 0x0036e000, 0x0f10030b, 0x00000000, 0x00000000, 0x00000000, 0x00000000
    .long 0x00ee3200, 0x00ee3200, 0x01049000, 0x0f10060c, 0x00000000, 0x00000000, 0x00000000, 0x00000000
    .long 0x0022b200, 0x002ab200, 0x0036e000, 0x0f10030b, 0x00000000, 0x00000000, 0x00000000, 0x00000000
    .long 0x00ee3600, 0x00ee3600, 0x01049000, 0x0f10060c, 0x00000000, 0x00000000, 0x00000000, 0x00000000
    .long 0x0022b600, 0x002ab600, 0x0036e000, 0x0f10030b, 0x00000000, 0x00000000, 0x00000000, 0x00000000
    .long 0x00ee3a00, 0x00f63a00, 0x01049000, 0x0f10060c, 0x00000000, 0x00000000, 0x00000000, 0x00000000
    .long 0x00d8f700, 0x00d8f700, 0x00ee3000, 0x0f10140b, 0x00000000, 0x00000000, 0x00000000, 0x00000000
    .long 0x00ee3e00, 0x00f63e00, 0x01049000, 0x0f10060c, 0x00000000, 0x00000000, 0x00000000, 0x00000000
    .long 0x00d8fb00, 0x00d8fb00, 0x00ee3000, 0x0f10140b, 0x00000000, 0x00000000, 0x00000000, 0x00000000
    .long 0x00ee3200, 0x00f63200, 0x01049000, 0x0f10060c, 0x00000000, 0x00000000, 0x00000000, 0x00000000
    .long 0x00d8ff00, 0x00d8ff00, 0x00ee3000, 0x0f10140b, 0x00000000, 0x00000000, 0x00000000, 0x00000000
    .long 0x00ee3600, 0x00f63600, 0x01049000, 0x0f10060c, 0x00000000, 0x00000000, 0x00000000, 0x00000000
    .long 0x00d8f300, 0x00d8f300, 0x00ee3000, 0x0f10140b, 0x00000000, 0x00000000, 0x00000000, 0x00000000
    .long 0x00ee3a00, 0x00fe3a00, 0x01049000, 0x0f10060c, 0x00000000, 0x00000000, 0x00000000, 0x00000000
    .long 0x0022bb00, 0x0022bb00, 0x0036e000, 0x0f10030b, 0x00000000, 0x00000000, 0x00000000, 0x00000000
    .long 0x00ee3e00, 0x00fe3e00, 0x01049000, 0x0f10060c, 0x00000000, 0x00000000, 0x00000000, 0x00000000
    .long 0x0022bf00, 0x0022bf00, 0x0036e000, 0x0f10030b, 0x00000000, 0x00000000, 0x00000000, 0x00000000
    .long 0x00ee3200, 0x00fe3200, 0x01049000, 0x0f10060c, 0x00000000, 0x00000000, 0x00000000, 0x00000000
    .long 0x0022b300, 0x0022b300, 0x0036e000, 0x0f10030b, 0x00000000, 0x00000000, 0x00000000, 0x00000000
    .long 0x00ee3600, 0x00fe3600, 0x01049000, 0x0f10060c, 0x00000000, 0x00000000, 0x00000000, 0x00000000
    .long 0x0022b700, 0x0022b700, 0x0036e000, 0x0f10030b, 0x00000000, 0x00000000, 0x00000000, 0x00000000
    .long 0x0036ec00, 0x004eec00, 0x00513000, 0x0ac0050e, 0x00000000, 0x00000000, 0x00000000, 0x00000000
    .long 0x00ee3900, 0x00ee3900, 0x01049000, 0x0f10060c, 0x00000000, 0x00000000, 0x00000000, 0x00000000
    .long 0x0036e000, 0x004ee000, 0x00513000, 0x0ac0050e, 0x00000000, 0x00000000, 0x00000000, 0x00000000
    .long 0x00ee3d00, 0x00ee3d00, 0x01049000, 0x0f10060c, 0x00000000, 0x00000000, 0x00000000, 0x00000000
    .long 0x0036e400, 0x004ee400, 0x00513000, 0x0ac0050e, 0x00000000, 0x00000000, 0x00000000, 0x00000000
    .long 0x00ee3100, 0x00ee3100, 0x01049000, 0x0f10060c, 0x00000000, 0x00000000, 0x00000000, 0x00000000
    .long 0x0036e800, 0x004ee800, 0x00513000, 0x0ac0050e, 0x00000000, 0x00000000, 0x00000000, 0x00000000
    .long 0x00ee3500, 0x00ee3500, 0x01049000, 0x0f10060c, 0x00000000, 0x00000000, 0x00000000, 0x00000000
    .long 0x00afac00, 0x00c7ac00, 0x00cb0000, 0x0ac0160e, 0x00000000, 0x00000000, 0x00000000, 0x00000000
    .long 0x00ee3900, 0x00f63900, 0x01049000, 0x0f10060c, 0x00000000, 0x00000000, 0x00000000, 0x00000000
    .long 0x00afa000, 0x00c7a000, 0x00cb0000, 0x0ac0160e, 0x00000000, 0x00000000, 0x00000000, 0x00000000
    .long 0x00ee3d00, 0x00f63d00, 0x01049000, 0x0f10060c, 0x00000000, 0x00000000, 0x00000000, 0x00000000
    .long 0x00afa400, 0x00c7a400, 0x00cb0000, 0x0ac0160e, 0x00000000, 0x00000000, 0x00000000, 0x00000000
    .long 0x00ee3100, 0x00f63100, 0x01049000, 0x0f10060c, 0x00000000, 0x00000000, 0x00000000, 0x00000000
    .long 0x00afa800, 0x00c7a800, 0x00cb0000, 0x0ac0160e, 0x00000000, 0x00000000, 0x00000000, 0x00000000
    .long 0x00ee3500, 0x00f63500, 0x01049000, 0x0f10060c, 0x00000000, 0x00000000, 0x00000000, 0x00000000
    .long 0x0036ed00, 0x004eed00, 0x00513000, 0x0ac0050e, 0x00000000, 0x00000000, 0x00000000, 0x00000000
    .long 0x0022bb00, 0x002abb00, 0x0036e000, 0x0f10030b, 0x00000000, 0x00000000, 0x00000000, 0x00000000
    .long 0x0036e100, 0x004ee100, 0x00513000, 0x0ac0050e, 0x00000000, 0x00000000, 0x00000000, 0x00000000
    .long 0x0022bf00, 0x002abf00, 0x0036e000, 0x0f10030b, 0x00000000, 0x00000000, 0x00000000, 0x00000000
    .long 0x0036e500, 0x004ee500, 0x00513000, 0x0ac0050e, 0x00000000, 0x00000000, 0x00000000, 0x00000000
    .long 0x0022b300, 0x002ab300, 0x0036e000, 0x0f10030b, 0x00000000, 0x00000000, 0x00000000, 0x00000000
    .long 0x0036e900, 0x004ee900, 0x00513000, 0x0ac0050e, 0x00000000, 0x00000000, 0x00000000, 0x00000000
    .long 0x0022b700, 0x002ab700, 0x0036e000, 0x0f10030b, 0x00000000, 0x00000000, 0x00000000, 0x00000000
    .long 0x00afad00, 0x00c7ad00, 0x00cb0000, 0x0ac0160e, 0x00000000, 0x00000000, 0x00000000, 0x00000000
    .long 0x00ee3900, 0x00fe3900, 0x01049000, 0x0f10060c, 0x00000000, 0x00000000, 0x00000000, 0x00000000
    .long 0x00afa100, 0x00c7a100, 0x00cb0000, 0x0ac0160e, 0x00000000, 0x00000000, 0x00000000, 0x00000000
    .long 0x00ee3d00, 0x00fe3d00, 0x01049000, 0x0f10060c, 0x00000000, 0x00000000, 0x00000000, 0x00000000
    .long 0x00afa500, 0x00c7a500, 0x00cb0000, 0x0ac0160e, 0x00000000, 0x00000000, 0x00000000, 0x00000000
    .long 0x00ee3100, 0x00fe3100, 0x01049000, 0x0f10060c, 0x00000000, 0x00000000, 0x00000000, 0x00000000
    .long 0x00afa900, 0x00c7a900, 0x00cb0000, 0x0ac0160e, 0x00000000, 0x00000000, 0x00000000, 0x00000000
    .long 0x00ee3500, 0x00fe3500, 0x01049000, 0x0f10060c, 0x00000000, 0x00000000, 0x00000000, 0x00000000
    .long 0x0092f400, 0x0092f400, 0x00a56000, 0x0a00070a, 0x00000000, 0x00000000, 0x00000000, 0x00000000
    .long 0x0036ee00, 0x004eee00, 0x00513000, 0x0ac0050e, 0x00000000, 0x00000000, 0x00000000, 0x00000000
    .long 0x0092f800, 0x0092f800, 0x00a56000, 0x0a00070a, 0x00000000, 0x00000000, 0x00000000, 0x00000000
    .long 0x0036e200, 0x004ee200, 0x00513000, 0x0ac0050e, 0x00000000, 0x00000000, 0x00000000, 0x00000000
    .long 0x0092fc00, 0x0092fc00, 0x00a56000, 0x0a00070a, 0x00000000, 0x00000000, 0x00000000, 0x00000000
    .long 0x0036e600, 0x004ee600, 0x00513000, 0x0ac0050e, 0x00000000, 0x00000000, 0x00000000, 0x00000000
    .long 0x0092f000, 0x0092f000, 0x00a56000, 0x0a00070a, 0x00000000, 0x00000000, 0x00000000, 0x00000000
    .long 0x0036ea00, 0x004eea00, 0x00513000, 0x0ac0050e, 0x00000000, 0x00000000, 0x00000000, 0x00000000
    .long 0x0092f400, 0x009af400, 0x00a56000, 0x0a00070a, 0x00000000, 0x00000000, 0x00000000, 0x00000000
    .long 0x0036ef00, 0x004eef00, 0x00513000, 0x0ac0050e, 0x00000000, 0x00000000, 0x00000000, 0x00000000
    .long 0x0092f800, 0x009af800, 0x00a56000, 0x0a00070a, 0x00000000, 0x00000000, 0x00000000, 0x00000000
    .long 0x0036e300, 0x004ee300, 0x00513000, 0x0ac0050e, 0x00000000, 0x00000000, 0x00000000, 0x00000000
    .long 0x0092fc00, 0x009afc00, 0x00a56000, 0x0a00070a, 0x00000000, 0x00000000, 0x00000000, 0x00000000
    .long 0x0036e700, 0x004ee700, 0x00513000, 0x0ac0050e, 0x00000000, 0x00000000, 0x00000000, 0x00000000
    .long 0x0092f000, 0x009af000, 0x00a56000, 0x0a00070a, 0x00000000, 0x00000000, 0x00000000, 0x00000000
    .long 0x0036eb00, 0x004eeb00, 0x00513000, 0x0ac0050e, 0x00000000, 0x00000000, 0x00000000, 0x00000000
    .long 0x0092f500, 0x0092f500, 0x00a56000, 0x0800070a, 0x00000000, 0x00000000, 0x00000000, 0x00000000
    .long 0x00afae00, 0x00c7ae00, 0x00cb0000, 0x0ac0160e, 0x00000000, 0x00000000, 0x00000000, 0x00000000
    .long 0x0092f900, 0x0092f900, 0x00a56000, 0x0800070a, 0x00000000, 0x00000000, 0x00000000, 0x00000000
    .long 0x00afa200, 0x00c7a200, 0x00cb0000, 0x0ac0160e, 0x00000000, 0x00000000, 0x00000000, 0x00000000
    .long 0x0092fd00, 0x0092fd00, 0x00a56000, 0x0800070a, 0x00000000, 0x00000000, 0x00000000, 0x00000000
    .long 0x00afa600, 0x00c7a600, 0x00cb0000, 0x0ac0160e, 0x00000000, 0x00000000, 0x00000000, 0x00000000
    .long 0x0092f100, 0x0092f100, 0x00a56000, 0x0800070a, 0x00000000, 0x00000000, 0x00000000, 0x00000000
    .long 0x00afaa00, 0x00c7aa00, 0x00cb0000, 0x0ac0160e, 0x00000000, 0x00000000, 0x00000000, 0x00000000
    .long 0x0092f500, 0x009af500, 0x00a56000, 0x0800070a, 0x00000000, 0x00000000, 0x00000000, 0x00000000
    .long 0x00afaf00, 0x00c7af00, 0x00cb0000, 0x0ac0160e, 0x00000000, 0x00000000, 0x00000000, 0x00000000
    .long 0x0092f900, 0x009af900, 0x00a56000, 0x0800070a, 0x00000000, 0x00000000, 0x00000000, 0x00000000
    .long 0x00afa300, 0x00c7a300, 0x00cb0000, 0x0ac0160e, 0x00000000, 0x00000000, 0x00000000, 0x00000000
    .long 0x0092fd00, 0x009afd00, 0x00a56000, 0x0800070a, 0x00000000, 0x00000000, 0x00000000, 0x00000000
    .long 0x00afa700, 0x00c7a700, 0x00cb0000, 0x0ac0160e, 0x00000000, 0x00000000, 0x00000000, 0x00000000
    .long 0x0092f100, 0x009af100, 0x00a56000, 0x0800070a, 0x00000000, 0x00000000, 0x00000000, 0x00000000
    .long 0x00afab00, 0x00c7ab00, 0x00cb0000, 0x0ac0160e, 0x00000000, 0x00000000, 0x00000000, 0x00000000
    .long 0x00d8f600, 0x00e8f600, 0x00ee3000, 0x0800140b, 0x00000000, 0x00000000, 0x00000000, 0x00000000
    .long 0x00756e00, 0x00756e00, 0x00885000, 0x08000f0a, 0x00000000, 0x00000000, 0x00000000, 0x00000000
    .long 0x00d8fa00, 0x00e8fa00, 0x00ee3000, 0x0800140b, 0x00000000, 0x00000000, 0x00000000, 0x00000000
    .long 0x00756200, 0x00756200, 0x00885000, 0x08000f0a, 0x00000000, 0x00000000, 0x00000000, 0x00000000
    .long 0x00d8fe00, 0x00e8fe00, 0x00ee3000, 0x0800140b, 0x00000000, 0x00000000, 0x00000000, 0x00000000
    .long 0x00756600, 0x00756600, 0x00885000, 0x08000f0a, 0x00000000, 0x00000000, 0x00000000, 0x00000000
    .long 0x00d8f200, 0x00e8f200, 0x00ee3000, 0x0800140b, 0x00000000, 0x00000000, 0x00000000, 0x00000000
    .long 0x00756a00, 0x00756a00, 0x00885000, 0x08000f0a, 0x00000000, 0x00000000, 0x00000000, 0x00000000
    .long 0x00000200, 0x00080200, 0x00141000, 0x0800010b, 0x00000000, 0x00000000, 0x00000000, 0x00000000
    .long 0x00756e00, 0x007d6e00, 0x00885000, 0x08000f0a, 0x00000000, 0x00000000, 0x00000000, 0x00000000
    .long 0x00000600, 0x00080600, 0x00141000, 0x0800010b, 0x00000000, 0x00000000, 0x00000000, 0x00000000
    .long 0x00756200, 0x007d6200, 0x00885000, 0x08000f0a, 0x00000000, 0x00000000, 0x00000000, 0x00000000
    .long 0x00000a00, 0x00080a00, 0x00141000, 0x0800010b, 0x00000000, 0x00000000, 0x00000000, 0x00000000
    .long 0x00756600, 0x007d6600, 0x00885000, 0x08000f0a, 0x00000000, 0x00000000, 0x00000000, 0x00000000
    .long 0x00000e00, 0x00080e00, 0x00141000, 0x0800010b, 0x00000000, 0x00000000, 0x00000000, 0x00000000
    .long 0x00756a00, 0x007d6a00, 0x00885000, 0x08000f0a, 0x00000000, 0x00000000, 0x00000000, 0x00000000
    .long 0x00000200, 0x00100200, 0x00141000, 0x0800010b, 0x00000000, 0x00000000, 0x00000000, 0x00000000
    .long 0x00756f00, 0x00756f00, 0x00885000, 0x08000f0a, 0x00000000, 0x00000000, 0x00000000, 0x00000000
    .long 0x00000600, 0x00100600, 0x00141000, 0x0800010b, 0x00000000, 0x00000000, 0x00000000, 0x00000000
    .long 0x00756300, 0x00756300, 0x00885000, 0x08000f0a, 0x00000000, 0x00000000, 0x00000000, 0x00000000
    .long 0x00000a00, 0x00100a00, 0x00141000, 0x0800010b, 0x00000000, 0x00000000, 0x00000000, 0x00000000
    .long 0x00756700, 0x00756700, 0x00885000, 0x08000f0a, 0x00000000, 0x00000000, 0x00000000, 0x00000000
    .long 0x00000e00, 0x00100e00, 0x00141000, 0x0800010b, 0x00000000, 0x00000000, 0x00000000, 0x00000000
    .long 0x00756b00, 0x00756b00, 0x00885000, 0x08000f0a, 0x00000000, 0x00000000, 0x00000000, 0x00000000
    .long 0x0022b800, 0x0022b800, 0x0036e000, 0x0800030b, 0x00000000, 0x00000000, 0x00000000, 0x00000000
    .long 0x00756f00, 0x007d6f00, 0x00885000, 0x08000f0a, 0x00000000, 0x00000000, 0x00000000, 0x00000000
    .long 0x0022bc00, 0x0022bc00, 0x0036e000, 0x0800030b, 0x00000000, 0x00000000, 0x00000000, 0x00000000
    .long 0x00756300, 0x007d6300, 0x00885000, 0x08000f0a, 0x00000000, 0x00000000, 0x00000000, 0x00000000
    .long 0x0022b000, 0x0022b000, 0x0036e000, 0x0800030b, 0x00000000, 0x00000000, 0x00000000, 0x00000000
    .long 0x00756700, 0x007d6700, 0x00885000, 0x08000f0a, 0x00000000, 0x00000000, 0x00000000, 0x00000000
    .long 0x0022b400, 0x0022b400, 0x0036e000, 0x0800030b, 0x00000000, 0x00000000, 0x00000000, 0x00000000
    .long 0x00756b00, 0x007d6b00, 0x00885000, 0x08000f0a, 0x00000000, 0x00000000, 0x00000000, 0x00000000
    .long 0x00d8f400, 0x00e8f400, 0x00ee3000, 0x0800140b, 0x00000000, 0x00000000, 0x00000000, 0x00000000
    .long 0x0092f600, 0x0092f600, 0x00a56000, 0x0800070a, 0x00000000, 0x00000000, 0x00000000, 0x00000000
    .long 0x00d8f800, 0x00e8f800, 0x00ee3000, 0x0800140b, 0x00000000, 0x00000000, 0x00000000, 0x00000000
    .long 0x0092fa00, 0x0092fa00, 0x00a56000, 0x0800070a, 0x00000000, 0x00000000, 0x00000000, 0x00000000
    .long 0x00d8fc00, 0x00e8fc00, 0x00ee3000, 0x0800140b, 0x00000000, 0x00000000, 0x00000000, 0x00000000
    .long 0x0092fe00, 0x0092fe00, 0x00a56000, 0x0800070a, 0x00000000, 0x00000000, 0x00000000, 0x00000000
    .long 0x00d8f000, 0x00e8f000, 0x00ee3000, 0x0800140b, 0x00000000, 0x00000000, 0x00000000, 0x00000000
    .long 0x0092f200, 0x0092f200, 0x00a56000, 0x0800070a, 0x00000000, 0x00000000, 0x00000000, 0x00000000
    .long 0x0022b800, 0x0032b800, 0x0036e000, 0x0800030b, 0x00000000, 0x00000000, 0x00000000, 0x00000000
    .long 0x0092f600, 0x009af600, 0x00a56000, 0x0800070a, 0x00000000, 0x00000000, 0x00000000, 0x00000000
    .long 0x0022bc00, 0x0032bc00, 0x0036e000, 0x0800030b, 0x00000000, 0x00000000, 0x00000000, 0x00000000
    .long 0x0092fa00, 0x009afa00, 0x00a56000, 0x0800070a, 0x00000000, 0x00000000, 0x00000000, 0x00000000
    .long 0x0022b000, 0x0032b000, 0x0036e000, 0x0800030b, 0x00000000, 0x00000000, 0x00000000, 0x00000000
    .long 0x0092fe00, 0x009afe00, 0x00a56000, 0x0800070a, 0x00000000, 0x00000000, 0x00000000, 0x00000000
    .long 0x0022b400, 0x0032b400, 0x0036e000, 0x0800030b, 0x00000000, 0x00000000, 0x00000000, 0x00000000
    .long 0x0092f200, 0x009af200, 0x00a56000, 0x0800070a, 0x00000000, 0x00000000, 0x00000000, 0x00000000
    .long 0x00d8f400, 0x00d8f400, 0x00ee3000, 0x0800140b, 0x00000000, 0x00000000, 0x00000000, 0x00000000
    .long 0x0092f700, 0x0092f700, 0x00a56000, 0x0800070a, 0x00000000, 0x00000000, 0x00000000, 0x00000000
    .long 0x00d8f800, 0x00d8f800, 0x00ee3000, 0x0800140b, 0x00000000, 0x00000000, 0x00000000, 0x00000000
    .long 0x0092fb00, 0x0092fb00, 0x00a56000, 0x0800070a, 0x00000000, 0x00000000, 0x00000000, 0x00000000
    .long 0x00d8fc00, 0x00d8fc00, 0x00ee3000, 0x0800140b, 0x00000000, 0x00000000, 0x00000000, 0x00000000
    .long 0x0092ff00, 0x0092ff00, 0x00a56000, 0x0800070a, 0x00000000, 0x00000000, 0x00000000, 0x00000000
    .long 0x00d8f000, 0x00d8f000, 0x00ee3000, 0x0800140b, 0x00000000, 0x00000000, 0x00000000, 0x00000000
    .long 0x0092f300, 0x0092f300, 0x00a56000, 0x0800070a, 0x00000000, 0x00000000, 0x00000000, 0x00000000
    .long 0x00d8f400, 0x00e0f400, 0x00ee3000, 0x0800140b, 0x00000000, 0x00000000, 0x00000000, 0x00000000
    .long 0x0092f700, 0x009af700, 0x00a56000, 0x0800070a, 0x00000000, 0x00000000, 0x00000000, 0x00000000
    .long 0x00d8f800, 0x00e0f800, 0x00ee3000, 0x0800140b, 0x00000000, 0x00000000, 0x00000000, 0x00000000
    .long 0x0092fb00, 0x009afb00, 0x00a56000, 0x0800070a, 0x00000000, 0x00000000, 0x00000000, 0x00000000
    .long 0x00d8fc00, 0x00e0fc00, 0x00ee3000, 0x0800140b, 0x00000000, 0x00000000, 0x00000000, 0x00000000
    .long 0x0092ff00, 0x009aff00, 0x00a56000, 0x0800070a, 0x00000000, 0x00000000, 0x00000000, 0x00000000
    .long 0x00d8f000, 0x00e0f000, 0x00ee3000, 0x0800140b, 0x00000000, 0x00000000, 0x00000000, 0x00000000
    .long 0x0092f300, 0x009af300, 0x00a56000, 0x0800070a, 0x00000000, 0x00000000, 0x00000000, 0x00000000
    .long 0x0022b800, 0x002ab800, 0x0036e000, 0x0800030b, 0x00000000, 0x00000000, 0x00000000, 0x00000000
    .long 0x0022bb00, 0x0032bb00, 0x0036e000, 0x0800030b, 0x00000000, 0x00000000, 0x00000000, 0x00000000
    .long 0x0022bc00, 0x002abc00, 0x0036e000, 0x0800030b, 0x00000000, 0x00000000, 0x00000000, 0x00000000
    .long 0x0022bf00, 0x0032bf00, 0x0036e000, 0x0800030b, 0x00000000, 0x00000000, 0x00000000, 0x00000000
    .long 0x0022b000, 0x002ab000, 0x0036e000, 0x0800030b, 0x00000000, 0x00000000, 0x00000000, 0x00000000
    .long 0x0022b300, 0x0032b300, 0x0036e000, 0x0800030b, 0x00000000, 0x00000000, 0x00000000, 0x00000000
    .long 0x0022b400, 0x002ab400, 0x0036e000, 0x0800030b, 0x00000000, 0x00000000, 0x00000000, 0x00000000
    .long 0x0022b700, 0x0032b700, 0x0036e000, 0x0800030b, 0x00000000, 0x00000000, 0x00000000, 0x00000000
    .long 0x00d8f600, 0x00d8f600, 0x00ee3000, 0x0800140b, 0x00000000, 0x00000000, 0x00000000, 0x00000000
    .long 0x0022ba00, 0x0032ba00, 0x0036e000, 0x0800030b, 0x00000000, 0x00000000, 0x00000000, 0x00000000
    .long 0x00d8fa00, 0x00d8fa00, 0x00ee3000, 0x0800140b, 0x00000000, 0x00000000, 0x00000000, 0x00000000
    .long 0x0022be00, 0x0032be00, 0x0036e000, 0x0800030b, 0x00000000, 0x00000000, 0x00000000, 0x00000000
    .long 0x00d8fe00, 0x00d8fe00, 0x00ee3000, 0x0800140b, 0x00000000, 0x00000000, 0x00000000, 0x00000000
    .long 0x0022b200, 0x0032b200, 0x0036e000, 0x0800030b, 0x00000000, 0x00000000, 0x00000000, 0x00000000
    .long 0x00d8f200, 0x00d8f200, 0x00ee3000, 0x0800140b, 0x00000000, 0x00000000, 0x00000000, 0x00000000
    .long 0x0022b600, 0x0032b600, 0x0036e000, 0x0800030b, 0x00000000, 0x00000000, 0x00000000, 0x00000000
    .long 0x00d8f600, 0x00e0f600, 0x00ee3000, 0x0800140b, 0x00000000, 0x00000000, 0x00000000, 0x00000000
    .long 0x00000300, 0x00100300, 0x00141000, 0x0800010b, 0x00000000, 0x00000000, 0x00000000, 0x00000000
    .long 0x00d8fa00, 0x00e0fa00, 0x00ee3000, 0x0800140b, 0x00000000, 0x00000000, 0x00000000, 0x00000000
    .long 0x00000700, 0x00100700, 0x00141000, 0x0800010b, 0x00000000, 0x00000000, 0x00000000, 0x00000000
    .long 0x00d8fe00, 0x00e0fe00, 0x00ee3000, 0x0800140b, 0x00000000, 0x00000000, 0x00000000, 0x00000000
    .long 0x00000b00, 0x00100b00, 0x00141000, 0x0800010b, 0x00000000, 0x00000000, 0x00000000, 0x00000000
    .long 0x00d8f200, 0x00e0f200, 0x00ee3000, 0x0800140b, 0x00000000, 0x00000000, 0x00000000, 0x00000000
    .long 0x00000f00, 0x00100f00, 0x00141000, 0x0800010b, 0x00000000, 0x00000000, 0x00000000, 0x00000000
    .long 0x00000200, 0x00000200, 0x00141000, 0x0800010b, 0x00000000, 0x00000000, 0x00000000, 0x00000000
    .long 0x00d8f700, 0x00e8f700, 0x00ee3000, 0x0800140b, 0x00000000, 0x00000000, 0x00000000, 0x00000000
    .long 0x00000600, 0x00000600, 0x00141000, 0x0800010b, 0x00000000, 0x00000000, 0x00000000, 0x00000000
    .long 0x00d8fb00, 0x00e8fb00, 0x00ee3000, 0x0800140b, 0x00000000, 0x00000000, 0x00000000, 0x00000000
    .long 0x00000a00, 0x00000a00, 0x00141000, 0x0800010b, 0x00000000, 0x00000000, 0x00000000, 0x00000000
    .long 0x00d8ff00, 0x00e8ff00, 0x00ee3000, 0x0800140b, 0x00000000, 0x00000000, 0x00000000, 0x00000000
    .long 0x00000e00, 0x00000e00, 0x00141000, 0x0800010b, 0x00000000, 0x00000000, 0x00000000, 0x00000000
    .long 0x00d8f300, 0x00e8f300, 0x00ee3000, 0x0800140b, 0x00000000, 0x00000000, 0x00000000, 0x00000000
.size L_table, 16384
.section .rodata,"a"
.p2align 6
.amdhsa_kernel standalone__varlen_attn_packed__ragged_kernel
  .amdhsa_next_free_vgpr 248
  .amdhsa_next_free_sgpr 80
  .amdhsa_accum_offset 248
  .amdhsa_group_segment_fixed_size 0
  .amdhsa_kernarg_size 56
  .amdhsa_user_sgpr_count 2
  .amdhsa_user_sgpr_kernarg_segment_ptr 1
  .amdhsa_system_sgpr_workgroup_id_x 1
.end_amdhsa_kernel
```
